```python
import torch

def _softmax(x, axis=-1):
    return torch.softmax(x, dim=axis)
def _gelu(x):
    return torch.nn.functional.gelu(x, approximate="tanh")
def _silu(x):
    return torch.nn.functional.silu(x)
def _sigmoid(x):
    return torch.sigmoid(x)
def _layernorm(x, axis=-1, eps=1e-5):
    m = x.mean(dim=axis, keepdim=True)
    v = x.var(dim=axis, keepdim=True, unbiased=False)
    return (x - m) / torch.sqrt(v + eps)
def _scatter_add(tgt, idx, src, axis=0):
    return tgt.clone().index_add_(axis, idx, src)
def _segment_sum(src, seg, n):
    out = torch.zeros((n,) + src.shape[1:], dtype=src.dtype)
    return out.index_add_(0, seg, src)
def _pad(x, pw):
    flat = tuple(v for pair in reversed(pw) for v in pair)
    return torch.nn.functional.pad(x, flat)

kernel_name = 'concat_heads__grouped_kv_mqa__sliding_block__prompt'

def setup_inputs():

    _w = (lambda a: (lambda t: t.to(torch.bfloat16) if t.is_floating_point() else t)(torch.as_tensor(a)))
    def _A_setup():
        B, S, D, H = 1, 2048, 512, 32
        Dh = D // H
        return {
            "x": _w((lambda *s: torch.randn(*s, dtype=torch.bfloat16) * 0.05)(B, S, D)),
            "wq": _w((lambda *s: torch.randn(*s, dtype=torch.bfloat16) * 3.2)(D, H * Dh)),
            "wk": _w((lambda *s: torch.randn(*s, dtype=torch.bfloat16) * 3.2)(D, Dh)),
            "wv": _w((lambda *s: torch.randn(*s, dtype=torch.bfloat16) * 1.6)(D, Dh)),
            "wo": _w((lambda *s: torch.randn(*s, dtype=torch.bfloat16) * 1.6)(H * Dh, D)),
        }
    _A_in = _A_setup()

    def _B_setup():
        B, S, D = 1, 2048, 512
        return {
            "x": _w((lambda *s: torch.randn(*s, dtype=torch.bfloat16) * 0.1)(B, S, D)),
            "wqkv": _w((lambda *s: torch.randn(*s, dtype=torch.bfloat16) * 0.8)(D, 3 * D)),
            "wo": _w((lambda *s: torch.randn(*s, dtype=torch.bfloat16) * 0.8)(D, D)),
        }
    _B_in = _B_setup()

    return {
        "A_x": _A_in["x"],
        "A_wq": _A_in["wq"],
        "A_wk": _A_in["wk"],
        "A_wv": _A_in["wv"],
        "A_wo": _A_in["wo"],
        "B_x": _B_in["x"],
        "B_wqkv": _B_in["wqkv"],
        "B_wo": _B_in["wo"],
    }

def reference(A_x, A_wq, A_wk, A_wv, A_wo, B_x, B_wqkv, B_wo):
    def _A_ref(x, wq, wk, wv, wo):
        B, S, D = x.shape
        H = 32
        Dh = D // H
        q = (lambda x, *d: x.permute(*d))((x @ wq).reshape(B, S, H, Dh), 0, 2, 1, 3)
        k = x @ wk
        v = x @ wv
        scores = torch.einsum("bhqd,bkd->bhqk", q, k) * (Dh ** -0.5)
        p = _softmax(scores, axis=-1)
        o = torch.einsum("bhqk,bkd->bhqd", p, v)
        return (lambda x, *d: x.permute(*d))(o, 0, 2, 1, 3).reshape(B, S, H * Dh) @ wo

    def _B_ref(x, wqkv, wo):
        B, S, D = x.shape
        H = 32; Dh = D // H; W = 256
        qkv = (lambda x, *d: x.permute(*d))((x @ wqkv).reshape(B, S, 3, H, Dh), 2, 0, 3, 1, 4)
        q, k, v = qkv[0], qkv[1], qkv[2]
        scores = torch.einsum("bhqd,bhkd->bhqk", q, k) * (Dh ** -0.5)
        idx = torch.arange(S)
        mask = (idx[:, None] - idx[None, :] >= 0) & (idx[:, None] - idx[None, :] < W)
        scores = torch.where(mask[None, None], scores, -1e9)
        p = _softmax(scores, axis=-1)
        o = torch.einsum("bhqk,bhkd->bhqd", p, v)
        return (lambda x, *d: x.permute(*d))(o, 0, 2, 1, 3).reshape(B, S, D) @ wo

    a = _A_ref(A_x, A_wq, A_wk, A_wv, A_wo)
    b = _B_ref(B_x, B_wqkv, B_wo)
    return torch.concatenate([a, b], axis=-1)
```

```asm
; @launch grid=(256,1,1) block=(512,1,1) lds=163840
  .amdgcn_target "amdgcn-amd-amdhsa--gfx950"
  .text
  .globl concat_heads__grouped_kv_mqa__sliding_block__prompt_kernel
  .p2align 8
  .type concat_heads__grouped_kv_mqa__sliding_block__prompt_kernel,@function
concat_heads__grouped_kv_mqa__sliding_block__prompt_kernel:
  s_cmp_ge_u32 s2, 256
  s_cbranch_scc1 L_end
  s_load_dwordx16 s[4:19], s[0:1], 0
  s_load_dwordx4 s[20:23], s[0:1], 64
  s_load_dwordx2 s[24:25], s[0:1], 80
  v_lshrrev_b32 v1, 6, v0
  v_and_b32 v0, 63, v0
  s_lshr_b32 s68, s2, 3
  v_readfirstlane_b32 s3, v1
  s_and_b32 s69, s2, 7
  s_lshr_b32 s74, s68, 3
  s_lshl_b32 s70, s69, 2
  s_add_u32 s70, s70, s74
  s_and_b32 s71, s68, 7
  s_lshr_b32 s72, s69, 1
  s_lshl_b32 s72, s72, 2
  s_add_u32 s72, s72, s74
  s_and_b32 s75, s69, 1
  s_lshl_b32 s73, s75, 3
  s_add_u32 s73, s73, s71
  s_lshl_b32 s83, s72, 1
  s_add_u32 s83, s83, s75
  s_lshl_b32 s76, s3, 10
  v_lshrrev_b32 v21, 3, v0
  v_and_b32 v22, 7, v0
  v_lshrrev_b32 v23, 4, v0
  s_lshl_b32 s74, s3, 2
  v_add_u32 v1, s74, v23
  v_and_b32 v1, 7, v1
  v_xor_b32 v1, v1, v22
  v_lshlrev_b32 v1, 4, v1
  v_lshl_add_u32 v2, v21, 10, v1
  s_lshl_b32 s74, s70, 16
  s_lshl_b32 s75, s3, 13
  s_add_u32 s74, s74, s75
  v_add_u32 v2, s74, v2
  s_and_b32 s74, s3, 1
  s_lshl_b32 s74, s74, 2
  v_and_b32 v1, 1, v23
  v_lshlrev_b32 v1, 1, v1
  v_or_b32 v1, s74, v1
  v_xor_b32 v1, v1, v22
  v_lshlrev_b32 v1, 4, v1
  v_lshl_add_u32 v3, v21, 10, v1
  s_lshl_b32 s74, s71, 7
  s_add_u32 s74, s74, s75
  v_add_u32 v3, s74, v3
  s_waitcnt lgkmcnt(0)
  s_mov_b32 s28, s4
  s_mov_b32 s29, s5
  s_mov_b32 s30, 2097152
  s_mov_b32 s31, 0x20000
  s_mov_b32 s32, s6
  s_mov_b32 s33, s7
  s_mov_b32 s34, 524288
  s_mov_b32 s35, 0x20000
  s_add_u32 m0, s76, 0
  s_mov_b32 s74, 0
  buffer_load_dwordx4 v2, s[28:31], s74 offen lds
  s_add_u32 m0, s76, 8192
  s_mov_b32 s74, 0
  buffer_load_dwordx4 v3, s[32:35], s74 offen lds
  s_add_u32 m0, s76, 16384
  s_mov_b32 s74, 128
  buffer_load_dwordx4 v2, s[28:31], s74 offen lds
  s_add_u32 m0, s76, 24576
  s_mov_b32 s74, 65536
  buffer_load_dwordx4 v3, s[32:35], s74 offen lds
  s_bitcmp1_b32 s71, 0
  s_cselect_b32 s36, s10, s8
  s_cselect_b32 s37, s11, s9
  s_mov_b32 s38, 16384
  s_mov_b32 s39, 0x20000
  s_lshl_b32 s75, s3, 11
  v_lshl_add_u32 v4, v0, 4, s75
  s_add_u32 m0, s75, 131072
  s_nop 0
  buffer_load_dwordx4 v4, s[36:39], 0 offen lds
  buffer_load_dwordx4 v4, s[36:39], 0 offen offset:1024 lds
  s_mov_b32 s40, s14
  s_mov_b32 s41, s15
  s_mov_b32 s42, 2097152
  s_mov_b32 s43, 0x20000
  s_mov_b32 s44, s16
  s_mov_b32 s45, s17
  s_mov_b32 s46, 1572864
  s_mov_b32 s47, 0x20000
  s_mov_b32 s48, s12
  s_mov_b32 s49, s13
  s_mov_b32 s50, 524288
  s_mov_b32 s51, 0x20000
  s_mov_b32 s52, s18
  s_mov_b32 s53, s19
  s_mov_b32 s54, 524288
  s_mov_b32 s55, 0x20000
  s_mov_b32 s56, s20
  s_mov_b32 s57, s21
  s_mov_b32 s58, 4194304
  s_mov_b32 s59, 0x20000
  s_mov_b32 s60, s22
  s_mov_b32 s61, s23
  s_mov_b32 s62, 256
  s_mov_b32 s63, 0x20000
  s_mov_b32 s64, s24
  s_mov_b32 s65, s25
  s_mov_b32 s66, 11534336
  s_mov_b32 s67, 0x20000
  s_cmp_lg_u32 s2, 0
  s_cbranch_scc1 L_noinit
  s_cmp_lg_u32 s3, 7
  s_cbranch_scc1 L_noinit
  v_lshlrev_b32 v1, 8, v0
  v_mov_b32 v24, 0
  buffer_store_dword v24, v1, s[64:67], 0 offen sc1
  v_mov_b32 v25, 1
  s_waitcnt vmcnt(0)
  buffer_store_dword v25, v24, s[60:63], 0 offen sc1
  s_waitcnt vmcnt(0)
L_noinit:
  s_add_u32 m0, s76, 32768
  s_mov_b32 s74, 256
  buffer_load_dwordx4 v2, s[28:31], s74 offen lds
  s_add_u32 m0, s76, 40960
  s_mov_b32 s74, 131072
  buffer_load_dwordx4 v3, s[32:35], s74 offen lds
  s_add_u32 m0, s76, 49152
  s_mov_b32 s74, 384
  buffer_load_dwordx4 v2, s[28:31], s74 offen lds
  s_add_u32 m0, s76, 57344
  s_mov_b32 s74, 196608
  buffer_load_dwordx4 v3, s[32:35], s74 offen lds
  s_cmp_lt_u32 s3, 2
  s_cselect_b32 s96, s40, s44
  s_cselect_b32 s97, s41, s45
  s_cselect_b32 s98, s42, s46
  s_cselect_b32 s99, s43, s47
  s_mov_b32 s74, 128
  s_cselect_b32 s81, s74, 196608
  s_add_u32 s88, s3, 0
  s_lshl_b32 s74, s88, 10
  s_mov_b32 s77, s74
  s_lshl_b32 s74, s88, 2
  v_add_u32 v1, s74, v23
  v_and_b32 v1, 7, v1
  v_xor_b32 v1, v1, v22
  v_lshlrev_b32 v1, 4, v1
  v_lshl_add_u32 v1, v21, 10, v1
  s_lshl_b32 s74, s72, 17
  s_lshl_b32 s75, s88, 13
  s_add_u32 s74, s74, s75
  v_add_u32 v5, s74, v1
  s_add_u32 s88, s3, 7
  s_lshl_b32 s74, s88, 10
  s_mov_b32 s78, s74
  s_lshl_b32 s74, s88, 2
  v_add_u32 v1, s74, v23
  v_and_b32 v1, 7, v1
  v_xor_b32 v1, v1, v22
  v_lshlrev_b32 v1, 4, v1
  v_lshl_add_u32 v1, v21, 10, v1
  s_lshl_b32 s74, s72, 17
  s_lshl_b32 s75, s88, 13
  s_add_u32 s74, s74, s75
  v_add_u32 v6, s74, v1
  s_add_u32 s88, s3, 14
  s_lshl_b32 s74, s88, 10
  s_mov_b32 s79, s74
  s_lshl_b32 s74, s88, 2
  v_add_u32 v1, s74, v23
  v_and_b32 v1, 7, v1
  v_xor_b32 v1, v1, v22
  v_lshlrev_b32 v1, 4, v1
  v_lshl_add_u32 v1, v21, 10, v1
  s_lshl_b32 s74, s72, 17
  s_lshl_b32 s75, s88, 13
  s_add_u32 s74, s74, s75
  v_add_u32 v7, s74, v1
  s_cmp_lt_u32 s3, 2
  s_cbranch_scc1 L_skw
  s_sub_u32 s74, s88, 16
  s_lshl_b32 s74, s74, 6
  v_add_u32 v1, s74, v0
  v_mul_u32_u24 v24, 5462, v1
  v_lshrrev_b32 v24, 16, v24
  v_mul_u32_u24 v25, 12, v24
  v_sub_u32 v1, v1, v25
  v_lshrrev_b32 v25, 2, v24
  v_and_b32 v25, 2, v25
  v_xor_b32 v1, v1, v25
  v_mul_u32_u24 v24, 3072, v24
  v_lshrrev_b32 v25, 2, v1
  v_lshl_add_u32 v24, v25, 10, v24
  v_and_b32 v1, 3, v1
  v_lshl_add_u32 v24, v1, 4, v24
  s_lshl_b32 s74, s73, 6
  v_add_u32 v7, s74, v24
L_skw:
  s_add_u32 s88, s3, 21
  s_lshl_b32 s74, s88, 10
  s_mov_b32 s80, s74
  s_sub_u32 s74, s88, 16
  s_lshl_b32 s74, s74, 6
  v_add_u32 v1, s74, v0
  v_mul_u32_u24 v24, 5462, v1
  v_lshrrev_b32 v24, 16, v24
  v_mul_u32_u24 v25, 12, v24
  v_sub_u32 v1, v1, v25
  v_lshrrev_b32 v25, 2, v24
  v_and_b32 v25, 2, v25
  v_xor_b32 v1, v1, v25
  v_mul_u32_u24 v24, 3072, v24
  v_lshrrev_b32 v25, 2, v1
  v_lshl_add_u32 v24, v25, 10, v24
  v_and_b32 v1, 3, v1
  v_lshl_add_u32 v24, v1, 4, v24
  s_lshl_b32 s74, s73, 6
  v_add_u32 v8, s74, v24
  s_add_u32 m0, s76, 65536
  s_mov_b32 s74, 512
  buffer_load_dwordx4 v2, s[28:31], s74 offen lds
  s_add_u32 m0, s76, 73728
  s_mov_b32 s74, 262144
  buffer_load_dwordx4 v3, s[32:35], s74 offen lds
  s_add_u32 m0, s76, 81920
  s_mov_b32 s74, 640
  buffer_load_dwordx4 v2, s[28:31], s74 offen lds
  s_add_u32 m0, s76, 90112
  s_mov_b32 s74, 327680
  buffer_load_dwordx4 v3, s[32:35], s74 offen lds
  v_and_b32 v24, 15, v0
  v_bfe_u32 v25, v0, 1, 3
  v_xor_b32 v25, v25, v23
  v_lshlrev_b32 v25, 4, v25
  v_lshl_add_u32 v25, v24, 7, v25
  s_and_b32 s74, s3, 1
  s_lshl_b32 s74, s74, 12
  v_add_u32 v9, s74, v25
  s_lshr_b32 s74, s71, 1
  s_lshl_b32 s74, s74, 11
  v_add_u32 v12, s74, v25
  s_and_b32 s74, s3, 3
  s_lshl_b32 s74, s74, 12
  v_add_u32 v124, s74, v25
  v_bfe_u32 v26, v0, 2, 2
  v_lshl_add_u32 v27, v23, 3, v26
  v_and_b32 v28, 3, v0
  v_lshlrev_b32 v28, 3, v28
  v_and_b32 v29, 1, v23
  v_lshrrev_b32 v30, 1, v26
  v_lshl_or_b32 v30, v29, 1, v30
  s_lshr_b32 s74, s3, 1
  v_xor_b32 v30, s74, v30
  v_lshl_add_u32 v30, v30, 5, v28
  v_lshl_add_u32 v11, v27, 7, v30
  v_add_u32 v11, 8192, v11
  v_lshl_add_u32 v14, v27, 5, v28
  v_add_u32 v14, 131072, v14
  s_lshr_b32 s74, s3, 2
  v_xor_b32 v29, s74, v29
  v_lshl_add_u32 v29, v29, 5, v28
  v_mul_u32_u24 v27, 192, v27
  v_add3_u32 v125, v27, v29, 0
  v_add_u32 v125, 16384, v125
  v_xor_b32 v10, 64, v9
  v_xor_b32 v13, 64, v12
  s_add_u32 m0, s76, 98304
  s_mov_b32 s74, 768
  buffer_load_dwordx4 v2, s[28:31], s74 offen lds
  s_add_u32 m0, s76, 106496
  s_mov_b32 s74, 393216
  buffer_load_dwordx4 v3, s[32:35], s74 offen lds
  s_add_u32 m0, s76, 114688
  s_mov_b32 s74, 896
  buffer_load_dwordx4 v2, s[28:31], s74 offen lds
  s_add_u32 m0, s76, 122880
  s_mov_b32 s74, 458752
  buffer_load_dwordx4 v3, s[32:35], s74 offen lds
  s_cmp_ge_u32 s3, 2
  s_cbranch_scc1 L_pf1
  s_lshr_b32 s74, s69, 1
  s_lshl_b32 s74, s74, 12
  s_lshl_b32 s75, s68, 7
  s_add_u32 s74, s74, s75
  s_lshl_b32 s75, s3, 6
  s_add_u32 s74, s74, s75
  v_add_lshl_u32 v1, s74, v0, 7
  buffer_load_dword v240, v1, s[40:43], 0 offen
  s_branch L_pfd
L_pf1:
  s_cmp_ge_u32 s3, 5
  s_cbranch_scc1 L_pf2
  s_mul_i32 s74, s68, 192
  s_lshl_b32 s75, s3, 6
  s_add_u32 s74, s74, s75
  s_sub_u32 s74, s74, 128
  v_add_u32 v1, s74, v0
  v_mul_u32_u24 v241, 5462, v1
  v_lshrrev_b32 v241, 16, v241
  v_mul_u32_u24 v242, 12, v241
  v_sub_u32 v1, v1, v242
  v_mul_u32_u24 v241, 3072, v241
  v_lshrrev_b32 v242, 2, v1
  v_lshl_add_u32 v241, v242, 10, v241
  v_and_b32 v1, 3, v1
  v_lshl_add_u32 v1, v1, 7, v241
  s_and_b32 s74, s69, 1
  s_lshl_b32 s74, s74, 9
  buffer_load_dword v240, v1, s[44:47], s74 offen
  s_branch L_pfd
L_pf2:
  s_cmp_ge_u32 s3, 6
  s_cbranch_scc1 L_pf3
  v_mul_u32_u24 v1, 163840, v0
  buffer_load_dword v240, v1, s[64:67], 0 offen
  s_branch L_pfd
L_pf3:
  v_lshlrev_b32 v1, 16, v0
  buffer_load_dword v240, v1, s[56:59], 0 offen
L_pfd:
  v_mov_b64 v[80:81], 0
  v_mov_b64 v[82:83], 0
  v_mov_b64 v[84:85], 0
  v_mov_b64 v[86:87], 0
  v_mov_b64 v[88:89], 0
  v_mov_b64 v[90:91], 0
  v_mov_b64 v[92:93], 0
  v_mov_b64 v[94:95], 0
  v_mov_b64 v[96:97], 0
  v_mov_b64 v[98:99], 0
  v_mov_b64 v[100:101], 0
  v_mov_b64 v[102:103], 0
  v_mov_b64 v[104:105], 0
  v_mov_b64 v[106:107], 0
  v_mov_b64 v[108:109], 0
  v_mov_b64 v[110:111], 0
  v_mov_b64 v[112:113], 0
  v_mov_b64 v[114:115], 0
  s_waitcnt vmcnt(13)
  s_barrier
  v_add_u32 v15, 0, v9
  v_add_u32 v16, 0, v10
  v_add_u32 v17, 0, v11
  v_add_u32 v18, 0, v12
  v_add_u32 v19, 0, v13
  s_cmp_eq_u32 s3, 7
  s_cbranch_scc1 L_w7_0
  ds_read_b128 v[24:27], v15 offset:0
  ds_read_b128 v[28:31], v15 offset:2048
  ds_read_b64_tr_b16 v[32:33], v17 offset:0
  ds_read_b64_tr_b16 v[34:35], v17 offset:512
  ds_read_b128 v[36:39], v16 offset:0
  ds_read_b128 v[40:43], v16 offset:2048
  ds_read_b64_tr_b16 v[44:45], v17 offset:4096
  ds_read_b64_tr_b16 v[46:47], v17 offset:4608
  ds_read_b128 v[48:51], v15 offset:16384
  ds_read_b128 v[52:55], v15 offset:18432
  ds_read_b64_tr_b16 v[56:57], v17 offset:16384
  ds_read_b64_tr_b16 v[58:59], v17 offset:16896
  ds_read_b128 v[60:63], v16 offset:16384
  ds_read_b128 v[64:67], v16 offset:18432
  ds_read_b64_tr_b16 v[68:69], v17 offset:20480
  ds_read_b64_tr_b16 v[70:71], v17 offset:20992
  s_branch L_j0
L_w7_0:
  ds_read_b128 v[176:179], v18 offset:0
  ds_read_b64_tr_b16 v[180:181], v14 offset:0
  ds_read_b64_tr_b16 v[182:183], v14 offset:128
  ds_read_b128 v[184:187], v19 offset:0
  ds_read_b64_tr_b16 v[188:189], v14 offset:1024
  ds_read_b64_tr_b16 v[190:191], v14 offset:1152
  ds_read_b128 v[192:195], v18 offset:16384
  ds_read_b64_tr_b16 v[196:197], v14 offset:2048
  ds_read_b64_tr_b16 v[198:199], v14 offset:2176
  ds_read_b128 v[200:203], v19 offset:16384
  ds_read_b64_tr_b16 v[204:205], v14 offset:3072
  ds_read_b64_tr_b16 v[206:207], v14 offset:3200
  ds_read_b128 v[24:27], v15 offset:0
  ds_read_b128 v[28:31], v15 offset:2048
  ds_read_b64_tr_b16 v[32:33], v17 offset:0
  ds_read_b64_tr_b16 v[34:35], v17 offset:512
  ds_read_b128 v[36:39], v16 offset:0
  ds_read_b128 v[40:43], v16 offset:2048
  ds_read_b64_tr_b16 v[44:45], v17 offset:4096
  ds_read_b64_tr_b16 v[46:47], v17 offset:4608
  ds_read_b128 v[48:51], v15 offset:16384
  ds_read_b128 v[52:55], v15 offset:18432
  ds_read_b64_tr_b16 v[56:57], v17 offset:16384
  ds_read_b64_tr_b16 v[58:59], v17 offset:16896
  ds_read_b128 v[60:63], v16 offset:16384
  ds_read_b128 v[64:67], v16 offset:18432
  ds_read_b64_tr_b16 v[68:69], v17 offset:20480
  ds_read_b64_tr_b16 v[70:71], v17 offset:20992
  s_waitcnt vmcnt(9)
L_j0:
  s_waitcnt lgkmcnt(0)
  s_waitcnt vmcnt(9)
  s_barrier
  s_cmp_eq_u32 s3, 7
  s_cbranch_scc1 L_w7_1
  v_mfma_f32_16x16x32_bf16 v[80:83], v[32:35], v[24:27], v[80:83]
  s_add_u32 m0, s77, 0
  s_mov_b32 s74, 0
  buffer_load_dwordx4 v5, s[40:43], s74 offen lds
  s_add_u32 m0, s78, 0
  s_mov_b32 s74, 0
  buffer_load_dwordx4 v6, s[40:43], s74 offen lds
  s_add_u32 m0, s79, 0
  s_mul_i32 s74, s81, 0
  buffer_load_dwordx4 v7, s[96:99], s74 offen lds
  v_mfma_f32_16x16x32_bf16 v[84:87], v[32:35], v[28:31], v[84:87]
  s_add_u32 m0, s80, 0
  s_mov_b32 s74, 0
  buffer_load_dwordx4 v8, s[44:47], s74 offen lds
  ds_read_b128 v[128:131], v15 offset:32768
  ds_read_b128 v[132:135], v15 offset:34816
  v_mfma_f32_16x16x32_bf16 v[80:83], v[44:47], v[36:39], v[80:83]
  ds_read_b64_tr_b16 v[136:137], v17 offset:32768
  ds_read_b64_tr_b16 v[138:139], v17 offset:33280
  ds_read_b128 v[140:143], v16 offset:32768
  v_mfma_f32_16x16x32_bf16 v[84:87], v[44:47], v[40:43], v[84:87]
  ds_read_b128 v[144:147], v16 offset:34816
  ds_read_b64_tr_b16 v[148:149], v17 offset:36864
  ds_read_b64_tr_b16 v[150:151], v17 offset:37376
  v_mfma_f32_16x16x32_bf16 v[80:83], v[56:59], v[48:51], v[80:83]
  ds_read_b128 v[152:155], v15 offset:49152
  ds_read_b128 v[156:159], v15 offset:51200
  ds_read_b64_tr_b16 v[160:161], v17 offset:49152
  v_mfma_f32_16x16x32_bf16 v[84:87], v[56:59], v[52:55], v[84:87]
  ds_read_b64_tr_b16 v[162:163], v17 offset:49664
  ds_read_b128 v[164:167], v16 offset:49152
  ds_read_b128 v[168:171], v16 offset:51200
  v_mfma_f32_16x16x32_bf16 v[80:83], v[68:71], v[60:63], v[80:83]
  ds_read_b64_tr_b16 v[172:173], v17 offset:53248
  ds_read_b64_tr_b16 v[174:175], v17 offset:53760
  v_mfma_f32_16x16x32_bf16 v[84:87], v[68:71], v[64:67], v[84:87]
  s_branch L_j1
L_w7_1:
  ds_read_b128 v[208:211], v18 offset:32768
  ds_read_b64_tr_b16 v[212:213], v14 offset:4096
  ds_read_b64_tr_b16 v[214:215], v14 offset:4224
  ds_read_b128 v[216:219], v19 offset:32768
  ds_read_b64_tr_b16 v[220:221], v14 offset:5120
  ds_read_b64_tr_b16 v[222:223], v14 offset:5248
  ds_read_b128 v[224:227], v18 offset:49152
  ds_read_b64_tr_b16 v[228:229], v14 offset:6144
  ds_read_b64_tr_b16 v[230:231], v14 offset:6272
  ds_read_b128 v[232:235], v19 offset:49152
  ds_read_b64_tr_b16 v[236:237], v14 offset:7168
  ds_read_b64_tr_b16 v[238:239], v14 offset:7296
  v_mfma_f32_16x16x32_bf16 v[80:83], v[32:35], v[24:27], v[80:83]
  ds_read_b128 v[128:131], v15 offset:32768
  ds_read_b128 v[132:135], v15 offset:34816
  v_mfma_f32_16x16x32_bf16 v[84:87], v[32:35], v[28:31], v[84:87]
  ds_read_b64_tr_b16 v[136:137], v17 offset:32768
  ds_read_b64_tr_b16 v[138:139], v17 offset:33280
  v_mfma_f32_16x16x32_bf16 v[80:83], v[44:47], v[36:39], v[80:83]
  ds_read_b128 v[140:143], v16 offset:32768
  ds_read_b128 v[144:147], v16 offset:34816
  v_mfma_f32_16x16x32_bf16 v[84:87], v[44:47], v[40:43], v[84:87]
  ds_read_b64_tr_b16 v[148:149], v17 offset:36864
  ds_read_b64_tr_b16 v[150:151], v17 offset:37376
  v_mfma_f32_16x16x32_bf16 v[80:83], v[56:59], v[48:51], v[80:83]
  ds_read_b128 v[152:155], v15 offset:49152
  ds_read_b128 v[156:159], v15 offset:51200
  v_mfma_f32_16x16x32_bf16 v[84:87], v[56:59], v[52:55], v[84:87]
  ds_read_b64_tr_b16 v[160:161], v17 offset:49152
  ds_read_b64_tr_b16 v[162:163], v17 offset:49664
  v_mfma_f32_16x16x32_bf16 v[80:83], v[68:71], v[60:63], v[80:83]
  ds_read_b128 v[164:167], v16 offset:49152
  ds_read_b128 v[168:171], v16 offset:51200
  v_mfma_f32_16x16x32_bf16 v[84:87], v[68:71], v[64:67], v[84:87]
  ds_read_b64_tr_b16 v[172:173], v17 offset:53248
  ds_read_b64_tr_b16 v[174:175], v17 offset:53760
  s_bitcmp1_b32 s71, 0
  s_cbranch_scc1 L_kv0
  v_mfma_f32_16x16x32_bf16 v[88:91], v[180:183], v[176:179], v[88:91]
  v_mfma_f32_16x16x32_bf16 v[88:91], v[188:191], v[184:187], v[88:91]
  v_mfma_f32_16x16x32_bf16 v[88:91], v[196:199], v[192:195], v[88:91]
  v_mfma_f32_16x16x32_bf16 v[88:91], v[204:207], v[200:203], v[88:91]
  s_branch L_kw0
L_kv0:
  v_mfma_f32_16x16x32_bf16 v[88:91], v[176:179], v[180:183], v[88:91]
  v_mfma_f32_16x16x32_bf16 v[88:91], v[184:187], v[188:191], v[88:91]
  v_mfma_f32_16x16x32_bf16 v[88:91], v[192:195], v[196:199], v[88:91]
  v_mfma_f32_16x16x32_bf16 v[88:91], v[200:203], v[204:207], v[88:91]
L_kw0:
  s_waitcnt vmcnt(5)
L_j1:
  s_waitcnt lgkmcnt(0)
  s_waitcnt vmcnt(9)
  s_barrier
  v_add_u32 v15, 65536, v9
  v_add_u32 v16, 65536, v10
  v_add_u32 v17, 65536, v11
  v_add_u32 v18, 65536, v12
  v_add_u32 v19, 65536, v13
  s_cmp_eq_u32 s3, 7
  s_cbranch_scc1 L_w7_2
  v_mfma_f32_16x16x32_bf16 v[80:83], v[136:139], v[128:131], v[80:83]
  s_add_u32 m0, s77, 32768
  s_mov_b32 s74, 128
  buffer_load_dwordx4 v5, s[40:43], s74 offen lds
  s_add_u32 m0, s78, 32768
  s_mov_b32 s74, 128
  buffer_load_dwordx4 v6, s[40:43], s74 offen lds
  s_add_u32 m0, s79, 32768
  s_mul_i32 s74, s81, 1
  buffer_load_dwordx4 v7, s[96:99], s74 offen lds
  v_mfma_f32_16x16x32_bf16 v[84:87], v[136:139], v[132:135], v[84:87]
  s_add_u32 m0, s80, 32768
  s_mov_b32 s74, 196608
  buffer_load_dwordx4 v8, s[44:47], s74 offen lds
  ds_read_b128 v[24:27], v15 offset:0
  ds_read_b128 v[28:31], v15 offset:2048
  v_mfma_f32_16x16x32_bf16 v[80:83], v[148:151], v[140:143], v[80:83]
  ds_read_b64_tr_b16 v[32:33], v17 offset:0
  ds_read_b64_tr_b16 v[34:35], v17 offset:512
  ds_read_b128 v[36:39], v16 offset:0
  v_mfma_f32_16x16x32_bf16 v[84:87], v[148:151], v[144:147], v[84:87]
  ds_read_b128 v[40:43], v16 offset:2048
  ds_read_b64_tr_b16 v[44:45], v17 offset:4096
  ds_read_b64_tr_b16 v[46:47], v17 offset:4608
  v_mfma_f32_16x16x32_bf16 v[80:83], v[160:163], v[152:155], v[80:83]
  ds_read_b128 v[48:51], v15 offset:16384
  ds_read_b128 v[52:55], v15 offset:18432
  ds_read_b64_tr_b16 v[56:57], v17 offset:16384
  v_mfma_f32_16x16x32_bf16 v[84:87], v[160:163], v[156:159], v[84:87]
  ds_read_b64_tr_b16 v[58:59], v17 offset:16896
  ds_read_b128 v[60:63], v16 offset:16384
  ds_read_b128 v[64:67], v16 offset:18432
  v_mfma_f32_16x16x32_bf16 v[80:83], v[172:175], v[164:167], v[80:83]
  ds_read_b64_tr_b16 v[68:69], v17 offset:20480
  ds_read_b64_tr_b16 v[70:71], v17 offset:20992
  v_mfma_f32_16x16x32_bf16 v[84:87], v[172:175], v[168:171], v[84:87]
  s_branch L_j2
L_w7_2:
  ds_read_b128 v[176:179], v18 offset:0
  ds_read_b64_tr_b16 v[180:181], v14 offset:8192
  ds_read_b64_tr_b16 v[182:183], v14 offset:8320
  ds_read_b128 v[184:187], v19 offset:0
  ds_read_b64_tr_b16 v[188:189], v14 offset:9216
  ds_read_b64_tr_b16 v[190:191], v14 offset:9344
  ds_read_b128 v[192:195], v18 offset:16384
  ds_read_b64_tr_b16 v[196:197], v14 offset:10240
  ds_read_b64_tr_b16 v[198:199], v14 offset:10368
  ds_read_b128 v[200:203], v19 offset:16384
  ds_read_b64_tr_b16 v[204:205], v14 offset:11264
  ds_read_b64_tr_b16 v[206:207], v14 offset:11392
  v_mfma_f32_16x16x32_bf16 v[80:83], v[136:139], v[128:131], v[80:83]
  ds_read_b128 v[24:27], v15 offset:0
  ds_read_b128 v[28:31], v15 offset:2048
  v_mfma_f32_16x16x32_bf16 v[84:87], v[136:139], v[132:135], v[84:87]
  ds_read_b64_tr_b16 v[32:33], v17 offset:0
  ds_read_b64_tr_b16 v[34:35], v17 offset:512
  v_mfma_f32_16x16x32_bf16 v[80:83], v[148:151], v[140:143], v[80:83]
  ds_read_b128 v[36:39], v16 offset:0
  ds_read_b128 v[40:43], v16 offset:2048
  v_mfma_f32_16x16x32_bf16 v[84:87], v[148:151], v[144:147], v[84:87]
  ds_read_b64_tr_b16 v[44:45], v17 offset:4096
  ds_read_b64_tr_b16 v[46:47], v17 offset:4608
  v_mfma_f32_16x16x32_bf16 v[80:83], v[160:163], v[152:155], v[80:83]
  ds_read_b128 v[48:51], v15 offset:16384
  ds_read_b128 v[52:55], v15 offset:18432
  v_mfma_f32_16x16x32_bf16 v[84:87], v[160:163], v[156:159], v[84:87]
  ds_read_b64_tr_b16 v[56:57], v17 offset:16384
  ds_read_b64_tr_b16 v[58:59], v17 offset:16896
  v_mfma_f32_16x16x32_bf16 v[80:83], v[172:175], v[164:167], v[80:83]
  ds_read_b128 v[60:63], v16 offset:16384
  ds_read_b128 v[64:67], v16 offset:18432
  v_mfma_f32_16x16x32_bf16 v[84:87], v[172:175], v[168:171], v[84:87]
  ds_read_b64_tr_b16 v[68:69], v17 offset:20480
  ds_read_b64_tr_b16 v[70:71], v17 offset:20992
  s_bitcmp1_b32 s71, 0
  s_cbranch_scc1 L_kv1
  v_mfma_f32_16x16x32_bf16 v[88:91], v[212:215], v[208:211], v[88:91]
  v_mfma_f32_16x16x32_bf16 v[88:91], v[220:223], v[216:219], v[88:91]
  v_mfma_f32_16x16x32_bf16 v[88:91], v[228:231], v[224:227], v[88:91]
  v_mfma_f32_16x16x32_bf16 v[88:91], v[236:239], v[232:235], v[88:91]
  s_branch L_kw1
L_kv1:
  v_mfma_f32_16x16x32_bf16 v[88:91], v[208:211], v[212:215], v[88:91]
  v_mfma_f32_16x16x32_bf16 v[88:91], v[216:219], v[220:223], v[88:91]
  v_mfma_f32_16x16x32_bf16 v[88:91], v[224:227], v[228:231], v[88:91]
  v_mfma_f32_16x16x32_bf16 v[88:91], v[232:235], v[236:239], v[88:91]
L_kw1:
  s_waitcnt vmcnt(1)
L_j2:
  s_waitcnt lgkmcnt(0)
  s_waitcnt vmcnt(9)
  s_barrier
  s_cmp_eq_u32 s3, 7
  s_cbranch_scc1 L_w7_3
  v_mfma_f32_16x16x32_bf16 v[80:83], v[32:35], v[24:27], v[80:83]
  s_add_u32 m0, s77, 65536
  s_mov_b32 s74, 256
  buffer_load_dwordx4 v5, s[40:43], s74 offen lds
  s_add_u32 m0, s78, 65536
  s_mov_b32 s74, 256
  buffer_load_dwordx4 v6, s[40:43], s74 offen lds
  s_add_u32 m0, s79, 65536
  s_mul_i32 s74, s81, 2
  buffer_load_dwordx4 v7, s[96:99], s74 offen lds
  v_mfma_f32_16x16x32_bf16 v[84:87], v[32:35], v[28:31], v[84:87]
  s_add_u32 m0, s80, 65536
  s_mov_b32 s74, 393216
  buffer_load_dwordx4 v8, s[44:47], s74 offen lds
  ds_read_b128 v[128:131], v15 offset:32768
  ds_read_b128 v[132:135], v15 offset:34816
  v_mfma_f32_16x16x32_bf16 v[80:83], v[44:47], v[36:39], v[80:83]
  ds_read_b64_tr_b16 v[136:137], v17 offset:32768
  ds_read_b64_tr_b16 v[138:139], v17 offset:33280
  ds_read_b128 v[140:143], v16 offset:32768
  v_mfma_f32_16x16x32_bf16 v[84:87], v[44:47], v[40:43], v[84:87]
  ds_read_b128 v[144:147], v16 offset:34816
  ds_read_b64_tr_b16 v[148:149], v17 offset:36864
  ds_read_b64_tr_b16 v[150:151], v17 offset:37376
  v_mfma_f32_16x16x32_bf16 v[80:83], v[56:59], v[48:51], v[80:83]
  ds_read_b128 v[152:155], v15 offset:49152
  ds_read_b128 v[156:159], v15 offset:51200
  ds_read_b64_tr_b16 v[160:161], v17 offset:49152
  v_mfma_f32_16x16x32_bf16 v[84:87], v[56:59], v[52:55], v[84:87]
  ds_read_b64_tr_b16 v[162:163], v17 offset:49664
  ds_read_b128 v[164:167], v16 offset:49152
  ds_read_b128 v[168:171], v16 offset:51200
  v_mfma_f32_16x16x32_bf16 v[80:83], v[68:71], v[60:63], v[80:83]
  ds_read_b64_tr_b16 v[172:173], v17 offset:53248
  ds_read_b64_tr_b16 v[174:175], v17 offset:53760
  v_mfma_f32_16x16x32_bf16 v[84:87], v[68:71], v[64:67], v[84:87]
  s_branch L_j3
L_w7_3:
  ds_read_b128 v[208:211], v18 offset:32768
  ds_read_b64_tr_b16 v[212:213], v14 offset:12288
  ds_read_b64_tr_b16 v[214:215], v14 offset:12416
  ds_read_b128 v[216:219], v19 offset:32768
  ds_read_b64_tr_b16 v[220:221], v14 offset:13312
  ds_read_b64_tr_b16 v[222:223], v14 offset:13440
  ds_read_b128 v[224:227], v18 offset:49152
  ds_read_b64_tr_b16 v[228:229], v14 offset:14336
  ds_read_b64_tr_b16 v[230:231], v14 offset:14464
  ds_read_b128 v[232:235], v19 offset:49152
  ds_read_b64_tr_b16 v[236:237], v14 offset:15360
  ds_read_b64_tr_b16 v[238:239], v14 offset:15488
  v_mfma_f32_16x16x32_bf16 v[80:83], v[32:35], v[24:27], v[80:83]
  ds_read_b128 v[128:131], v15 offset:32768
  ds_read_b128 v[132:135], v15 offset:34816
  v_mfma_f32_16x16x32_bf16 v[84:87], v[32:35], v[28:31], v[84:87]
  ds_read_b64_tr_b16 v[136:137], v17 offset:32768
  ds_read_b64_tr_b16 v[138:139], v17 offset:33280
  v_mfma_f32_16x16x32_bf16 v[80:83], v[44:47], v[36:39], v[80:83]
  ds_read_b128 v[140:143], v16 offset:32768
  ds_read_b128 v[144:147], v16 offset:34816
  v_mfma_f32_16x16x32_bf16 v[84:87], v[44:47], v[40:43], v[84:87]
  ds_read_b64_tr_b16 v[148:149], v17 offset:36864
  ds_read_b64_tr_b16 v[150:151], v17 offset:37376
  v_mfma_f32_16x16x32_bf16 v[80:83], v[56:59], v[48:51], v[80:83]
  ds_read_b128 v[152:155], v15 offset:49152
  ds_read_b128 v[156:159], v15 offset:51200
  v_mfma_f32_16x16x32_bf16 v[84:87], v[56:59], v[52:55], v[84:87]
  ds_read_b64_tr_b16 v[160:161], v17 offset:49152
  ds_read_b64_tr_b16 v[162:163], v17 offset:49664
  v_mfma_f32_16x16x32_bf16 v[80:83], v[68:71], v[60:63], v[80:83]
  ds_read_b128 v[164:167], v16 offset:49152
  ds_read_b128 v[168:171], v16 offset:51200
  v_mfma_f32_16x16x32_bf16 v[84:87], v[68:71], v[64:67], v[84:87]
  ds_read_b64_tr_b16 v[172:173], v17 offset:53248
  ds_read_b64_tr_b16 v[174:175], v17 offset:53760
  s_bitcmp1_b32 s71, 0
  s_cbranch_scc1 L_kv2
  v_mfma_f32_16x16x32_bf16 v[88:91], v[180:183], v[176:179], v[88:91]
  v_mfma_f32_16x16x32_bf16 v[88:91], v[188:191], v[184:187], v[88:91]
  v_mfma_f32_16x16x32_bf16 v[88:91], v[196:199], v[192:195], v[88:91]
  v_mfma_f32_16x16x32_bf16 v[88:91], v[204:207], v[200:203], v[88:91]
  s_branch L_kw2
L_kv2:
  v_mfma_f32_16x16x32_bf16 v[88:91], v[176:179], v[180:183], v[88:91]
  v_mfma_f32_16x16x32_bf16 v[88:91], v[184:187], v[188:191], v[88:91]
  v_mfma_f32_16x16x32_bf16 v[88:91], v[192:195], v[196:199], v[88:91]
  v_mfma_f32_16x16x32_bf16 v[88:91], v[200:203], v[204:207], v[88:91]
L_kw2:
L_j3:
  s_waitcnt lgkmcnt(0)
  s_waitcnt vmcnt(8)
  s_barrier
  v_mov_b32 v9, v124
  v_mov_b32 v11, v125
  v_xor_b32 v10, 64, v124
  v_add_u32 v15, 0, v9
  v_add_u32 v16, 0, v10
  v_add_u32 v17, 0, v11
  s_cmp_eq_u32 s3, 7
  s_cbranch_scc1 L_w7_4
  v_mfma_f32_16x16x32_bf16 v[80:83], v[136:139], v[128:131], v[80:83]
  s_add_u32 m0, s77, 98304
  s_mov_b32 s74, 384
  buffer_load_dwordx4 v5, s[40:43], s74 offen lds
  s_add_u32 m0, s78, 98304
  s_mov_b32 s74, 384
  buffer_load_dwordx4 v6, s[40:43], s74 offen lds
  s_add_u32 m0, s79, 98304
  s_mul_i32 s74, s81, 3
  buffer_load_dwordx4 v7, s[96:99], s74 offen lds
  v_mfma_f32_16x16x32_bf16 v[84:87], v[136:139], v[132:135], v[84:87]
  s_add_u32 m0, s80, 98304
  s_mov_b32 s74, 589824
  buffer_load_dwordx4 v8, s[44:47], s74 offen lds
  s_add_u32 m0, s77, 131072
  s_mov_b32 s74, 512
  buffer_load_dwordx4 v5, s[40:43], s74 offen lds
  s_add_u32 m0, s78, 131072
  s_mov_b32 s74, 512
  buffer_load_dwordx4 v6, s[40:43], s74 offen lds
  v_mfma_f32_16x16x32_bf16 v[80:83], v[148:151], v[140:143], v[80:83]
  s_add_u32 m0, s79, 131072
  s_mul_i32 s74, s81, 4
  buffer_load_dwordx4 v7, s[96:99], s74 offen lds
  s_add_u32 m0, s80, 131072
  s_mov_b32 s74, 786432
  buffer_load_dwordx4 v8, s[44:47], s74 offen lds
  ds_read_b128 v[24:27], v15 offset:0
  v_mfma_f32_16x16x32_bf16 v[84:87], v[148:151], v[144:147], v[84:87]
  ds_read_b128 v[28:31], v15 offset:2048
  ds_read_b64_tr_b16 v[32:33], v17 offset:0
  ds_read_b64_tr_b16 v[34:35], v17 offset:768
  v_mfma_f32_16x16x32_bf16 v[80:83], v[160:163], v[152:155], v[80:83]
  ds_read_b64_tr_b16 v[36:37], v17 offset:64
  ds_read_b64_tr_b16 v[38:39], v17 offset:832
  ds_read_b64_tr_b16 v[40:41], v17 offset:128
  v_mfma_f32_16x16x32_bf16 v[84:87], v[160:163], v[156:159], v[84:87]
  ds_read_b64_tr_b16 v[42:43], v17 offset:896
  ds_read_b128 v[44:47], v16 offset:0
  ds_read_b128 v[48:51], v16 offset:2048
  v_mfma_f32_16x16x32_bf16 v[80:83], v[172:175], v[164:167], v[80:83]
  ds_read_b64_tr_b16 v[52:53], v17 offset:6144
  ds_read_b64_tr_b16 v[54:55], v17 offset:6912
  ds_read_b64_tr_b16 v[56:57], v17 offset:6208
  v_mfma_f32_16x16x32_bf16 v[84:87], v[172:175], v[168:171], v[84:87]
  ds_read_b64_tr_b16 v[58:59], v17 offset:6976
  ds_read_b64_tr_b16 v[60:61], v17 offset:6272
  ds_read_b64_tr_b16 v[62:63], v17 offset:7040
  s_branch L_j4
L_w7_4:
  v_mfma_f32_16x16x32_bf16 v[80:83], v[136:139], v[128:131], v[80:83]
  ds_read_b128 v[24:27], v15 offset:0
  ds_read_b128 v[28:31], v15 offset:2048
  v_mfma_f32_16x16x32_bf16 v[84:87], v[136:139], v[132:135], v[84:87]
  ds_read_b64_tr_b16 v[32:33], v17 offset:0
  ds_read_b64_tr_b16 v[34:35], v17 offset:768
  v_mfma_f32_16x16x32_bf16 v[80:83], v[148:151], v[140:143], v[80:83]
  ds_read_b64_tr_b16 v[36:37], v17 offset:64
  ds_read_b64_tr_b16 v[38:39], v17 offset:832
  v_mfma_f32_16x16x32_bf16 v[84:87], v[148:151], v[144:147], v[84:87]
  ds_read_b64_tr_b16 v[40:41], v17 offset:128
  ds_read_b64_tr_b16 v[42:43], v17 offset:896
  v_mfma_f32_16x16x32_bf16 v[80:83], v[160:163], v[152:155], v[80:83]
  ds_read_b128 v[44:47], v16 offset:0
  ds_read_b128 v[48:51], v16 offset:2048
  v_mfma_f32_16x16x32_bf16 v[84:87], v[160:163], v[156:159], v[84:87]
  ds_read_b64_tr_b16 v[52:53], v17 offset:6144
  ds_read_b64_tr_b16 v[54:55], v17 offset:6912
  v_mfma_f32_16x16x32_bf16 v[80:83], v[172:175], v[164:167], v[80:83]
  ds_read_b64_tr_b16 v[56:57], v17 offset:6208
  ds_read_b64_tr_b16 v[58:59], v17 offset:6976
  v_mfma_f32_16x16x32_bf16 v[84:87], v[172:175], v[168:171], v[84:87]
  ds_read_b64_tr_b16 v[60:61], v17 offset:6272
  ds_read_b64_tr_b16 v[62:63], v17 offset:7040
  s_bitcmp1_b32 s71, 0
  s_cbranch_scc1 L_kv3
  v_mfma_f32_16x16x32_bf16 v[88:91], v[212:215], v[208:211], v[88:91]
  v_mfma_f32_16x16x32_bf16 v[88:91], v[220:223], v[216:219], v[88:91]
  v_mfma_f32_16x16x32_bf16 v[88:91], v[228:231], v[224:227], v[88:91]
  v_mfma_f32_16x16x32_bf16 v[88:91], v[236:239], v[232:235], v[88:91]
  s_branch L_kw3
L_kv3:
  v_mfma_f32_16x16x32_bf16 v[88:91], v[208:211], v[212:215], v[88:91]
  v_mfma_f32_16x16x32_bf16 v[88:91], v[216:219], v[220:223], v[88:91]
  v_mfma_f32_16x16x32_bf16 v[88:91], v[224:227], v[228:231], v[88:91]
  v_mfma_f32_16x16x32_bf16 v[88:91], v[232:235], v[236:239], v[88:91]
L_kw3:
L_j4:
  s_waitcnt lgkmcnt(0)
  s_nop 7
  v_mul_f32 v80, 0x3eb8aa3b, v80
  v_mul_f32 v81, 0x3eb8aa3b, v81
  v_mul_f32 v82, 0x3eb8aa3b, v82
  v_mul_f32 v83, 0x3eb8aa3b, v83
  v_mul_f32 v84, 0x3eb8aa3b, v84
  v_mul_f32 v85, 0x3eb8aa3b, v85
  v_mul_f32 v86, 0x3eb8aa3b, v86
  v_mul_f32 v87, 0x3eb8aa3b, v87
  v_cvt_pk_bf16_f32 v116, v80, v81
  v_cvt_pk_bf16_f32 v117, v82, v83
  v_cvt_pk_bf16_f32 v118, v84, v85
  v_cvt_pk_bf16_f32 v119, v86, v87
  s_nop 1
  v_permlane16_swap_b32 v116, v118
  v_permlane16_swap_b32 v117, v119
  s_cmp_lg_u32 s3, 7
  s_cbranch_scc1 L_n7s
  v_cvt_pk_bf16_f32 v88, v88, v89
  v_cvt_pk_bf16_f32 v89, v90, v91
  s_lshl_b32 s74, s70, 1
  s_lshr_b32 s75, s71, 2
  s_add_u32 s74, s74, s75
  s_lshl_b32 s74, s74, 10
  s_bfe_u32 s75, s71, 0x10001
  s_bitcmp1_b32 s71, 0
  s_cselect_b32 s88, 9, 8
  s_cselect_b32 s89, 8, 9
  s_cselect_b32 s90, 2, 1
  s_lshl_b32 s90, s90, 16
  s_lshl_b32 s75, s75, s88
  s_add_u32 s74, s74, s75
  s_add_u32 s74, s74, s90
  v_lshrrev_b32 v1, 5, v0
  v_lshlrev_b32 v1, s89, v1
  v_and_b32 v90, 15, v0
  v_lshl_add_u32 v1, v90, 4, v1
  v_and_b32 v90, 1, v23
  v_lshl_add_u32 v1, v90, 3, v1
  buffer_store_dwordx2 v[88:89], v1, s[64:67], s74 offen sc1
  v_mov_b32 v91, 0
  buffer_load_dword v90, v91, s[60:63], 0 offen sc1
L_n7s:
  s_waitcnt vmcnt(12)
  s_barrier
  s_cmp_eq_u32 s3, 7
  s_cbranch_scc1 L_w7_5
  v_mfma_f32_16x16x32_bf16 v[92:95], v[32:35], v[24:27], v[92:95]
  s_add_u32 m0, s77, 0
  s_mov_b32 s74, 640
  buffer_load_dwordx4 v5, s[40:43], s74 offen lds
  s_add_u32 m0, s78, 0
  s_mov_b32 s74, 640
  buffer_load_dwordx4 v6, s[40:43], s74 offen lds
  v_mfma_f32_16x16x32_bf16 v[96:99], v[32:35], v[28:31], v[96:99]
  s_add_u32 m0, s79, 0
  s_mul_i32 s74, s81, 5
  buffer_load_dwordx4 v7, s[96:99], s74 offen lds
  s_add_u32 m0, s80, 0
  s_mov_b32 s74, 983040
  buffer_load_dwordx4 v8, s[44:47], s74 offen lds
  v_mfma_f32_16x16x32_bf16 v[100:103], v[36:39], v[24:27], v[100:103]
  ds_read_b128 v[128:131], v15 offset:32768
  ds_read_b128 v[132:135], v15 offset:34816
  v_mfma_f32_16x16x32_bf16 v[104:107], v[36:39], v[28:31], v[104:107]
  ds_read_b64_tr_b16 v[136:137], v17 offset:32768
  ds_read_b64_tr_b16 v[138:139], v17 offset:33536
  v_mfma_f32_16x16x32_bf16 v[108:111], v[24:27], v[40:43], v[108:111]
  ds_read_b64_tr_b16 v[140:141], v17 offset:32832
  ds_read_b64_tr_b16 v[142:143], v17 offset:33600
  v_mfma_f32_16x16x32_bf16 v[112:115], v[28:31], v[40:43], v[112:115]
  ds_read_b64_tr_b16 v[144:145], v17 offset:32896
  ds_read_b64_tr_b16 v[146:147], v17 offset:33664
  v_mfma_f32_16x16x32_bf16 v[92:95], v[52:55], v[44:47], v[92:95]
  ds_read_b128 v[148:151], v16 offset:32768
  ds_read_b128 v[152:155], v16 offset:34816
  v_mfma_f32_16x16x32_bf16 v[96:99], v[52:55], v[48:51], v[96:99]
  ds_read_b64_tr_b16 v[156:157], v17 offset:38912
  ds_read_b64_tr_b16 v[158:159], v17 offset:39680
  v_mfma_f32_16x16x32_bf16 v[100:103], v[56:59], v[44:47], v[100:103]
  ds_read_b64_tr_b16 v[160:161], v17 offset:38976
  ds_read_b64_tr_b16 v[162:163], v17 offset:39744
  v_mfma_f32_16x16x32_bf16 v[104:107], v[56:59], v[48:51], v[104:107]
  ds_read_b64_tr_b16 v[164:165], v17 offset:39040
  ds_read_b64_tr_b16 v[166:167], v17 offset:39808
  v_mfma_f32_16x16x32_bf16 v[108:111], v[44:47], v[60:63], v[108:111]
  v_mfma_f32_16x16x32_bf16 v[112:115], v[48:51], v[60:63], v[112:115]
  s_branch L_j5
L_w7_5:
  v_mfma_f32_16x16x32_bf16 v[92:95], v[32:35], v[24:27], v[92:95]
  ds_read_b128 v[128:131], v15 offset:32768
  ds_read_b128 v[132:135], v15 offset:34816
  v_mfma_f32_16x16x32_bf16 v[96:99], v[32:35], v[28:31], v[96:99]
  ds_read_b64_tr_b16 v[136:137], v17 offset:32768
  ds_read_b64_tr_b16 v[138:139], v17 offset:33536
  v_mfma_f32_16x16x32_bf16 v[100:103], v[36:39], v[24:27], v[100:103]
  ds_read_b64_tr_b16 v[140:141], v17 offset:32832
  ds_read_b64_tr_b16 v[142:143], v17 offset:33600
  v_mfma_f32_16x16x32_bf16 v[104:107], v[36:39], v[28:31], v[104:107]
  ds_read_b64_tr_b16 v[144:145], v17 offset:32896
  ds_read_b64_tr_b16 v[146:147], v17 offset:33664
  v_mfma_f32_16x16x32_bf16 v[108:111], v[24:27], v[40:43], v[108:111]
  ds_read_b128 v[148:151], v16 offset:32768
  ds_read_b128 v[152:155], v16 offset:34816
  v_mfma_f32_16x16x32_bf16 v[112:115], v[28:31], v[40:43], v[112:115]
  ds_read_b64_tr_b16 v[156:157], v17 offset:38912
  ds_read_b64_tr_b16 v[158:159], v17 offset:39680
  v_mfma_f32_16x16x32_bf16 v[92:95], v[52:55], v[44:47], v[92:95]
  ds_read_b64_tr_b16 v[160:161], v17 offset:38976
  ds_read_b64_tr_b16 v[162:163], v17 offset:39744
  v_mfma_f32_16x16x32_bf16 v[96:99], v[52:55], v[48:51], v[96:99]
  ds_read_b64_tr_b16 v[164:165], v17 offset:39040
  ds_read_b64_tr_b16 v[166:167], v17 offset:39808
  v_mfma_f32_16x16x32_bf16 v[100:103], v[56:59], v[44:47], v[100:103]
  v_mfma_f32_16x16x32_bf16 v[104:107], v[56:59], v[48:51], v[104:107]
  v_mfma_f32_16x16x32_bf16 v[108:111], v[44:47], v[60:63], v[108:111]
  v_mfma_f32_16x16x32_bf16 v[112:115], v[48:51], v[60:63], v[112:115]
L_j5:
  s_waitcnt lgkmcnt(0)
  s_cmp_lg_u32 s3, 7
  s_cbranch_scc1 L_n7g
  s_mov_b32 s87, 0x40000
  s_branch L_pw1
L_pl1:
  buffer_load_dword v90, v91, s[60:63], 0 offen sc1
L_pw1:
  s_waitcnt vmcnt(0)
  v_cmp_ne_u32 vcc, 1, v90
  s_sub_u32 s87, s87, 1
  s_cbranch_scc1 L_pd1
  s_cbranch_vccnz L_pl1
L_pd1:
  s_and_b32 s74, s2, 7
  s_lshl_b32 s74, s74, 8
  v_mov_b32 v1, 1
  v_mov_b32 v254, 0
  s_mov_b64 exec, 1
  buffer_atomic_add v1, v254, s[64:67], s74 offen sc1
  s_mov_b64 exec, -1
L_n7g:
  s_waitcnt vmcnt(12)
  s_barrier
  v_add_u32 v15, 65536, v9
  v_add_u32 v16, 65536, v10
  v_add_u32 v17, 65536, v11
  s_cmp_eq_u32 s3, 7
  s_cbranch_scc1 L_w7_6
  v_mfma_f32_16x16x32_bf16 v[92:95], v[136:139], v[128:131], v[92:95]
  s_add_u32 m0, s77, 32768
  s_mov_b32 s74, 768
  buffer_load_dwordx4 v5, s[40:43], s74 offen lds
  s_add_u32 m0, s78, 32768
  s_mov_b32 s74, 768
  buffer_load_dwordx4 v6, s[40:43], s74 offen lds
  v_mfma_f32_16x16x32_bf16 v[96:99], v[136:139], v[132:135], v[96:99]
  s_add_u32 m0, s79, 32768
  s_mul_i32 s74, s81, 6
  buffer_load_dwordx4 v7, s[96:99], s74 offen lds
  s_add_u32 m0, s80, 32768
  s_mov_b32 s74, 1179648
  buffer_load_dwordx4 v8, s[44:47], s74 offen lds
  v_mfma_f32_16x16x32_bf16 v[100:103], v[140:143], v[128:131], v[100:103]
  ds_read_b128 v[24:27], v15 offset:0
  ds_read_b128 v[28:31], v15 offset:2048
  v_mfma_f32_16x16x32_bf16 v[104:107], v[140:143], v[132:135], v[104:107]
  ds_read_b64_tr_b16 v[32:33], v17 offset:0
  ds_read_b64_tr_b16 v[34:35], v17 offset:768
  v_mfma_f32_16x16x32_bf16 v[108:111], v[128:131], v[144:147], v[108:111]
  ds_read_b64_tr_b16 v[36:37], v17 offset:64
  ds_read_b64_tr_b16 v[38:39], v17 offset:832
  v_mfma_f32_16x16x32_bf16 v[112:115], v[132:135], v[144:147], v[112:115]
  ds_read_b64_tr_b16 v[40:41], v17 offset:128
  ds_read_b64_tr_b16 v[42:43], v17 offset:896
  v_mfma_f32_16x16x32_bf16 v[92:95], v[156:159], v[148:151], v[92:95]
  ds_read_b128 v[44:47], v16 offset:0
  ds_read_b128 v[48:51], v16 offset:2048
  v_mfma_f32_16x16x32_bf16 v[96:99], v[156:159], v[152:155], v[96:99]
  ds_read_b64_tr_b16 v[52:53], v17 offset:6144
  ds_read_b64_tr_b16 v[54:55], v17 offset:6912
  v_mfma_f32_16x16x32_bf16 v[100:103], v[160:163], v[148:151], v[100:103]
  ds_read_b64_tr_b16 v[56:57], v17 offset:6208
  ds_read_b64_tr_b16 v[58:59], v17 offset:6976
  v_mfma_f32_16x16x32_bf16 v[104:107], v[160:163], v[152:155], v[104:107]
  ds_read_b64_tr_b16 v[60:61], v17 offset:6272
  ds_read_b64_tr_b16 v[62:63], v17 offset:7040
  v_mfma_f32_16x16x32_bf16 v[108:111], v[148:151], v[164:167], v[108:111]
  v_mfma_f32_16x16x32_bf16 v[112:115], v[152:155], v[164:167], v[112:115]
  s_branch L_j6
L_w7_6:
  v_mfma_f32_16x16x32_bf16 v[92:95], v[136:139], v[128:131], v[92:95]
  ds_read_b128 v[24:27], v15 offset:0
  ds_read_b128 v[28:31], v15 offset:2048
  v_mfma_f32_16x16x32_bf16 v[96:99], v[136:139], v[132:135], v[96:99]
  ds_read_b64_tr_b16 v[32:33], v17 offset:0
  ds_read_b64_tr_b16 v[34:35], v17 offset:768
  v_mfma_f32_16x16x32_bf16 v[100:103], v[140:143], v[128:131], v[100:103]
  ds_read_b64_tr_b16 v[36:37], v17 offset:64
  ds_read_b64_tr_b16 v[38:39], v17 offset:832
  v_mfma_f32_16x16x32_bf16 v[104:107], v[140:143], v[132:135], v[104:107]
  ds_read_b64_tr_b16 v[40:41], v17 offset:128
  ds_read_b64_tr_b16 v[42:43], v17 offset:896
  v_mfma_f32_16x16x32_bf16 v[108:111], v[128:131], v[144:147], v[108:111]
  ds_read_b128 v[44:47], v16 offset:0
  ds_read_b128 v[48:51], v16 offset:2048
  v_mfma_f32_16x16x32_bf16 v[112:115], v[132:135], v[144:147], v[112:115]
  ds_read_b64_tr_b16 v[52:53], v17 offset:6144
  ds_read_b64_tr_b16 v[54:55], v17 offset:6912
  v_mfma_f32_16x16x32_bf16 v[92:95], v[156:159], v[148:151], v[92:95]
  ds_read_b64_tr_b16 v[56:57], v17 offset:6208
  ds_read_b64_tr_b16 v[58:59], v17 offset:6976
  v_mfma_f32_16x16x32_bf16 v[96:99], v[156:159], v[152:155], v[96:99]
  ds_read_b64_tr_b16 v[60:61], v17 offset:6272
  ds_read_b64_tr_b16 v[62:63], v17 offset:7040
  v_mfma_f32_16x16x32_bf16 v[100:103], v[160:163], v[148:151], v[100:103]
  v_mfma_f32_16x16x32_bf16 v[104:107], v[160:163], v[152:155], v[104:107]
  v_mfma_f32_16x16x32_bf16 v[108:111], v[148:151], v[164:167], v[108:111]
  v_mfma_f32_16x16x32_bf16 v[112:115], v[152:155], v[164:167], v[112:115]
L_j6:
  s_waitcnt lgkmcnt(0)
  s_waitcnt vmcnt(12)
  s_barrier
  s_cmp_eq_u32 s3, 7
  s_cbranch_scc1 L_w7_7
  v_mfma_f32_16x16x32_bf16 v[92:95], v[32:35], v[24:27], v[92:95]
  s_add_u32 m0, s77, 65536
  s_mov_b32 s74, 896
  buffer_load_dwordx4 v5, s[40:43], s74 offen lds
  s_add_u32 m0, s78, 65536
  s_mov_b32 s74, 896
  buffer_load_dwordx4 v6, s[40:43], s74 offen lds
  v_mfma_f32_16x16x32_bf16 v[96:99], v[32:35], v[28:31], v[96:99]
  s_add_u32 m0, s79, 65536
  s_mul_i32 s74, s81, 7
  buffer_load_dwordx4 v7, s[96:99], s74 offen lds
  s_add_u32 m0, s80, 65536
  s_mov_b32 s74, 1376256
  buffer_load_dwordx4 v8, s[44:47], s74 offen lds
  v_mfma_f32_16x16x32_bf16 v[100:103], v[36:39], v[24:27], v[100:103]
  ds_read_b128 v[128:131], v15 offset:32768
  ds_read_b128 v[132:135], v15 offset:34816
  v_mfma_f32_16x16x32_bf16 v[104:107], v[36:39], v[28:31], v[104:107]
  ds_read_b64_tr_b16 v[136:137], v17 offset:32768
  ds_read_b64_tr_b16 v[138:139], v17 offset:33536
  v_mfma_f32_16x16x32_bf16 v[108:111], v[24:27], v[40:43], v[108:111]
  ds_read_b64_tr_b16 v[140:141], v17 offset:32832
  ds_read_b64_tr_b16 v[142:143], v17 offset:33600
  v_mfma_f32_16x16x32_bf16 v[112:115], v[28:31], v[40:43], v[112:115]
  ds_read_b64_tr_b16 v[144:145], v17 offset:32896
  ds_read_b64_tr_b16 v[146:147], v17 offset:33664
  v_mfma_f32_16x16x32_bf16 v[92:95], v[52:55], v[44:47], v[92:95]
  ds_read_b128 v[148:151], v16 offset:32768
  ds_read_b128 v[152:155], v16 offset:34816
  v_mfma_f32_16x16x32_bf16 v[96:99], v[52:55], v[48:51], v[96:99]
  ds_read_b64_tr_b16 v[156:157], v17 offset:38912
  ds_read_b64_tr_b16 v[158:159], v17 offset:39680
  v_mfma_f32_16x16x32_bf16 v[100:103], v[56:59], v[44:47], v[100:103]
  ds_read_b64_tr_b16 v[160:161], v17 offset:38976
  ds_read_b64_tr_b16 v[162:163], v17 offset:39744
  v_mfma_f32_16x16x32_bf16 v[104:107], v[56:59], v[48:51], v[104:107]
  ds_read_b64_tr_b16 v[164:165], v17 offset:39040
  ds_read_b64_tr_b16 v[166:167], v17 offset:39808
  v_mfma_f32_16x16x32_bf16 v[108:111], v[44:47], v[60:63], v[108:111]
  v_mfma_f32_16x16x32_bf16 v[112:115], v[48:51], v[60:63], v[112:115]
  s_branch L_j7
L_w7_7:
  v_mfma_f32_16x16x32_bf16 v[92:95], v[32:35], v[24:27], v[92:95]
  ds_read_b128 v[128:131], v15 offset:32768
  ds_read_b128 v[132:135], v15 offset:34816
  v_mfma_f32_16x16x32_bf16 v[96:99], v[32:35], v[28:31], v[96:99]
  ds_read_b64_tr_b16 v[136:137], v17 offset:32768
  ds_read_b64_tr_b16 v[138:139], v17 offset:33536
  v_mfma_f32_16x16x32_bf16 v[100:103], v[36:39], v[24:27], v[100:103]
  ds_read_b64_tr_b16 v[140:141], v17 offset:32832
  ds_read_b64_tr_b16 v[142:143], v17 offset:33600
  v_mfma_f32_16x16x32_bf16 v[104:107], v[36:39], v[28:31], v[104:107]
  ds_read_b64_tr_b16 v[144:145], v17 offset:32896
  ds_read_b64_tr_b16 v[146:147], v17 offset:33664
  v_mfma_f32_16x16x32_bf16 v[108:111], v[24:27], v[40:43], v[108:111]
  ds_read_b128 v[148:151], v16 offset:32768
  ds_read_b128 v[152:155], v16 offset:34816
  v_mfma_f32_16x16x32_bf16 v[112:115], v[28:31], v[40:43], v[112:115]
  ds_read_b64_tr_b16 v[156:157], v17 offset:38912
  ds_read_b64_tr_b16 v[158:159], v17 offset:39680
  v_mfma_f32_16x16x32_bf16 v[92:95], v[52:55], v[44:47], v[92:95]
  ds_read_b64_tr_b16 v[160:161], v17 offset:38976
  ds_read_b64_tr_b16 v[162:163], v17 offset:39744
  v_mfma_f32_16x16x32_bf16 v[96:99], v[52:55], v[48:51], v[96:99]
  ds_read_b64_tr_b16 v[164:165], v17 offset:39040
  ds_read_b64_tr_b16 v[166:167], v17 offset:39808
  v_mfma_f32_16x16x32_bf16 v[100:103], v[56:59], v[44:47], v[100:103]
  v_mfma_f32_16x16x32_bf16 v[104:107], v[56:59], v[48:51], v[104:107]
  v_mfma_f32_16x16x32_bf16 v[108:111], v[44:47], v[60:63], v[108:111]
  v_mfma_f32_16x16x32_bf16 v[112:115], v[48:51], v[60:63], v[112:115]
L_j7:
  s_waitcnt lgkmcnt(0)
  s_lshl_b32 s91, s72, 2
  s_and_b32 s74, s3, 3
  s_add_u32 s91, s91, s74
  s_lshl_b32 s92, s73, 1
  s_lshr_b32 s74, s3, 2
  s_add_u32 s92, s92, s74
  s_lshl_b32 s93, s92, 6
  s_add_u32 s93, s93, s91
  v_lshlrev_b32 v2, 4, v0
  v_and_b32 v3, 1, v23
  v_lshrrev_b32 v4, 5, v0
  v_lshl_add_u32 v3, v3, 1, v4
  v_mul_u32_u24 v249, 272, v3
  v_and_b32 v5, 15, v0
  v_lshl_add_u32 v248, v5, 4, v249
  s_mul_i32 s74, s3, 3072
  s_add_u32 s74, s74, 94208
  v_add_u32 v243, s74, v2
  s_mul_i32 s74, s3, 5120
  s_add_u32 s74, s74, 118784
  v_add_u32 v245, s74, v2
  v_mul_u32_u24 v6, 272, v23
  v_lshl_add_u32 v6, v5, 4, v6
  s_mul_i32 s74, s3, 5440
  s_add_u32 s74, s74, 26112
  v_add_u32 v246, s74, v6
  s_mul_i32 s74, s3, 3264
  v_add_u32 v244, s74, v6
  s_mul_i32 s74, s3, 12
  v_min_u32 v6, 11, v5
  v_add_u32 v6, s74, v6
  v_mul_u32_u24 v6, 272, v6
  v_add_u32 v247, 256, v6
  v_and_b32 v1, 31, v0
  v_min_u32 v6, 19, v1
  s_mul_i32 s74, s3, 20
  s_add_u32 s74, s74, 96
  v_add_u32 v6, s74, v6
  v_mul_u32_u24 v6, 272, v6
  v_add_u32 v251, 256, v6
  v_min_u32 v1, 16, v1
  v_lshlrev_b32 v1, 4, v1
  v_mul_u32_u24 v3, 272, v4
  v_add_u32 v250, v3, v1
  v_mov_b32 v4, 0x3f803f80
  v_mov_b32 v5, v4
  v_mov_b32 v6, v4
  v_mov_b32 v7, v4
  s_waitcnt vmcnt(12)
  s_barrier
  v_add_u32 v15, 131072, v9
  v_add_u32 v16, 131072, v10
  v_add_u32 v17, 131072, v11
  v_mfma_f32_16x16x32_bf16 v[92:95], v[136:139], v[128:131], v[92:95]
  ds_read_b128 v[24:27], v15 offset:0
  ds_read_b128 v[28:31], v15 offset:2048
  v_mfma_f32_16x16x32_bf16 v[96:99], v[136:139], v[132:135], v[96:99]
  ds_read_b64_tr_b16 v[32:33], v17 offset:0
  ds_read_b64_tr_b16 v[34:35], v17 offset:768
  v_mfma_f32_16x16x32_bf16 v[100:103], v[140:143], v[128:131], v[100:103]
  ds_read_b64_tr_b16 v[36:37], v17 offset:64
  ds_read_b64_tr_b16 v[38:39], v17 offset:832
  v_mfma_f32_16x16x32_bf16 v[104:107], v[140:143], v[132:135], v[104:107]
  ds_read_b64_tr_b16 v[40:41], v17 offset:128
  ds_read_b64_tr_b16 v[42:43], v17 offset:896
  v_mfma_f32_16x16x32_bf16 v[108:111], v[128:131], v[144:147], v[108:111]
  ds_read_b128 v[44:47], v16 offset:0
  ds_read_b128 v[48:51], v16 offset:2048
  v_mfma_f32_16x16x32_bf16 v[112:115], v[132:135], v[144:147], v[112:115]
  ds_read_b64_tr_b16 v[52:53], v17 offset:6144
  ds_read_b64_tr_b16 v[54:55], v17 offset:6912
  v_mfma_f32_16x16x32_bf16 v[92:95], v[156:159], v[148:151], v[92:95]
  ds_read_b64_tr_b16 v[56:57], v17 offset:6208
  ds_read_b64_tr_b16 v[58:59], v17 offset:6976
  v_mfma_f32_16x16x32_bf16 v[96:99], v[156:159], v[152:155], v[96:99]
  ds_read_b64_tr_b16 v[60:61], v17 offset:6272
  ds_read_b64_tr_b16 v[62:63], v17 offset:7040
  v_mfma_f32_16x16x32_bf16 v[100:103], v[160:163], v[148:151], v[100:103]
  v_mfma_f32_16x16x32_bf16 v[104:107], v[160:163], v[152:155], v[104:107]
  v_mfma_f32_16x16x32_bf16 v[108:111], v[148:151], v[164:167], v[108:111]
  v_mfma_f32_16x16x32_bf16 v[112:115], v[152:155], v[164:167], v[112:115]
  s_waitcnt lgkmcnt(0)
  s_waitcnt vmcnt(8)
  s_barrier
  v_add_u32 v15, 0, v9
  v_add_u32 v16, 0, v10
  v_add_u32 v17, 0, v11
  v_mfma_f32_16x16x32_bf16 v[92:95], v[32:35], v[24:27], v[92:95]
  ds_read_b128 v[128:131], v15 offset:0
  ds_read_b128 v[132:135], v15 offset:2048
  v_mfma_f32_16x16x32_bf16 v[96:99], v[32:35], v[28:31], v[96:99]
  ds_read_b64_tr_b16 v[136:137], v17 offset:0
  ds_read_b64_tr_b16 v[138:139], v17 offset:768
  v_mfma_f32_16x16x32_bf16 v[100:103], v[36:39], v[24:27], v[100:103]
  ds_read_b64_tr_b16 v[140:141], v17 offset:64
  ds_read_b64_tr_b16 v[142:143], v17 offset:832
  v_mfma_f32_16x16x32_bf16 v[104:107], v[36:39], v[28:31], v[104:107]
  ds_read_b64_tr_b16 v[144:145], v17 offset:128
  ds_read_b64_tr_b16 v[146:147], v17 offset:896
  v_mfma_f32_16x16x32_bf16 v[108:111], v[24:27], v[40:43], v[108:111]
  ds_read_b128 v[148:151], v16 offset:0
  ds_read_b128 v[152:155], v16 offset:2048
  v_mfma_f32_16x16x32_bf16 v[112:115], v[28:31], v[40:43], v[112:115]
  ds_read_b64_tr_b16 v[156:157], v17 offset:6144
  ds_read_b64_tr_b16 v[158:159], v17 offset:6912
  v_mfma_f32_16x16x32_bf16 v[92:95], v[52:55], v[44:47], v[92:95]
  ds_read_b64_tr_b16 v[160:161], v17 offset:6208
  ds_read_b64_tr_b16 v[162:163], v17 offset:6976
  v_mfma_f32_16x16x32_bf16 v[96:99], v[52:55], v[48:51], v[96:99]
  ds_read_b64_tr_b16 v[164:165], v17 offset:6272
  ds_read_b64_tr_b16 v[166:167], v17 offset:7040
  v_mfma_f32_16x16x32_bf16 v[100:103], v[56:59], v[44:47], v[100:103]
  v_mfma_f32_16x16x32_bf16 v[104:107], v[56:59], v[48:51], v[104:107]
  v_mfma_f32_16x16x32_bf16 v[108:111], v[44:47], v[60:63], v[108:111]
  v_mfma_f32_16x16x32_bf16 v[112:115], v[48:51], v[60:63], v[112:115]
  s_waitcnt lgkmcnt(0)
  s_waitcnt vmcnt(4)
  s_barrier
  v_mfma_f32_16x16x32_bf16 v[92:95], v[136:139], v[128:131], v[92:95]
  ds_read_b128 v[24:27], v15 offset:32768
  ds_read_b128 v[28:31], v15 offset:34816
  v_mfma_f32_16x16x32_bf16 v[96:99], v[136:139], v[132:135], v[96:99]
  ds_read_b64_tr_b16 v[32:33], v17 offset:32768
  ds_read_b64_tr_b16 v[34:35], v17 offset:33536
  v_mfma_f32_16x16x32_bf16 v[100:103], v[140:143], v[128:131], v[100:103]
  ds_read_b64_tr_b16 v[36:37], v17 offset:32832
  ds_read_b64_tr_b16 v[38:39], v17 offset:33600
  v_mfma_f32_16x16x32_bf16 v[104:107], v[140:143], v[132:135], v[104:107]
  ds_read_b64_tr_b16 v[40:41], v17 offset:32896
  ds_read_b64_tr_b16 v[42:43], v17 offset:33664
  v_mfma_f32_16x16x32_bf16 v[108:111], v[128:131], v[144:147], v[108:111]
  ds_read_b128 v[44:47], v16 offset:32768
  ds_read_b128 v[48:51], v16 offset:34816
  v_mfma_f32_16x16x32_bf16 v[112:115], v[132:135], v[144:147], v[112:115]
  ds_read_b64_tr_b16 v[52:53], v17 offset:38912
  ds_read_b64_tr_b16 v[54:55], v17 offset:39680
  v_mfma_f32_16x16x32_bf16 v[92:95], v[156:159], v[148:151], v[92:95]
  ds_read_b64_tr_b16 v[56:57], v17 offset:38976
  ds_read_b64_tr_b16 v[58:59], v17 offset:39744
  v_mfma_f32_16x16x32_bf16 v[96:99], v[156:159], v[152:155], v[96:99]
  ds_read_b64_tr_b16 v[60:61], v17 offset:39040
  ds_read_b64_tr_b16 v[62:63], v17 offset:39808
  v_mfma_f32_16x16x32_bf16 v[100:103], v[160:163], v[148:151], v[100:103]
  v_mfma_f32_16x16x32_bf16 v[104:107], v[160:163], v[152:155], v[104:107]
  v_mfma_f32_16x16x32_bf16 v[108:111], v[148:151], v[164:167], v[108:111]
  v_mfma_f32_16x16x32_bf16 v[112:115], v[152:155], v[164:167], v[112:115]
  s_waitcnt lgkmcnt(0)
  s_cmp_lg_u32 s3, 7
  s_cbranch_scc1 L_n7p
  v_lshlrev_b32 v1, 8, v22
  s_mov_b32 s87, 0x40000
L_pl2:
  buffer_load_dword v176, v1, s[64:67], 0 offen sc1
L_pw2:
  s_waitcnt vmcnt(0)
  v_cmp_ne_u32 vcc, 32, v176
  s_sub_u32 s87, s87, 1
  s_cbranch_scc1 L_pd2
  s_cbranch_vccnz L_pl2
L_pd2:
L_n7p:
  s_waitcnt vmcnt(0)
  s_barrier
  v_add_u32 v15, 65536, v9
  v_add_u32 v16, 65536, v10
  v_add_u32 v17, 65536, v11
  s_mul_i32 s74, s3, 3072
  s_add_u32 s77, s74, 65536
  s_add_u32 s78, s74, 131072
  s_add_u32 s79, s77, 4096
  s_add_u32 s80, s78, 4096
  v_mfma_f32_16x16x32_bf16 v[92:95], v[32:35], v[24:27], v[92:95]
  ds_read_b128 v[128:131], v15 offset:0
  ds_read_b128 v[132:135], v15 offset:2048
  v_mfma_f32_16x16x32_bf16 v[96:99], v[32:35], v[28:31], v[96:99]
  ds_read_b64_tr_b16 v[136:137], v17 offset:0
  ds_read_b64_tr_b16 v[138:139], v17 offset:768
  v_mfma_f32_16x16x32_bf16 v[100:103], v[36:39], v[24:27], v[100:103]
  ds_read_b64_tr_b16 v[140:141], v17 offset:64
  ds_read_b64_tr_b16 v[142:143], v17 offset:832
  v_mfma_f32_16x16x32_bf16 v[104:107], v[36:39], v[28:31], v[104:107]
  ds_read_b64_tr_b16 v[144:145], v17 offset:128
  ds_read_b64_tr_b16 v[146:147], v17 offset:896
  v_mfma_f32_16x16x32_bf16 v[108:111], v[24:27], v[40:43], v[108:111]
  ds_read_b128 v[148:151], v16 offset:0
  ds_read_b128 v[152:155], v16 offset:2048
  v_mfma_f32_16x16x32_bf16 v[112:115], v[28:31], v[40:43], v[112:115]
  ds_read_b64_tr_b16 v[156:157], v17 offset:6144
  ds_read_b64_tr_b16 v[158:159], v17 offset:6912
  v_mfma_f32_16x16x32_bf16 v[92:95], v[52:55], v[44:47], v[92:95]
  ds_read_b64_tr_b16 v[160:161], v17 offset:6208
  ds_read_b64_tr_b16 v[162:163], v17 offset:6976
  v_mfma_f32_16x16x32_bf16 v[96:99], v[52:55], v[48:51], v[96:99]
  ds_read_b64_tr_b16 v[164:165], v17 offset:6272
  ds_read_b64_tr_b16 v[166:167], v17 offset:7040
  v_mfma_f32_16x16x32_bf16 v[100:103], v[56:59], v[44:47], v[100:103]
  buffer_load_dwordx4 v[176:179], v2, s[64:67], s77 offen offset:0 sc1
  buffer_load_dwordx4 v[180:183], v2, s[64:67], s78 offen offset:0 sc1
  v_mfma_f32_16x16x32_bf16 v[104:107], v[56:59], v[48:51], v[104:107]
  buffer_load_dwordx4 v[184:187], v2, s[64:67], s77 offen offset:1024 sc1
  buffer_load_dwordx4 v[188:191], v2, s[64:67], s78 offen offset:1024 sc1
  v_mfma_f32_16x16x32_bf16 v[108:111], v[44:47], v[60:63], v[108:111]
  buffer_load_dwordx4 v[192:195], v2, s[64:67], s77 offen offset:2048 sc1
  buffer_load_dwordx4 v[196:199], v2, s[64:67], s78 offen offset:2048 sc1
  v_mfma_f32_16x16x32_bf16 v[112:115], v[48:51], v[60:63], v[112:115]
  s_waitcnt lgkmcnt(0)
  v_mfma_f32_16x16x32_bf16 v[92:95], v[136:139], v[128:131], v[92:95]
  v_mfma_f32_16x16x32_bf16 v[96:99], v[136:139], v[132:135], v[96:99]
  v_mfma_f32_16x16x32_bf16 v[100:103], v[140:143], v[128:131], v[100:103]
  v_mfma_f32_16x16x32_bf16 v[104:107], v[140:143], v[132:135], v[104:107]
  v_mfma_f32_16x16x32_bf16 v[108:111], v[128:131], v[144:147], v[108:111]
  v_mfma_f32_16x16x32_bf16 v[112:115], v[132:135], v[144:147], v[112:115]
  v_mfma_f32_16x16x32_bf16 v[92:95], v[156:159], v[148:151], v[92:95]
  v_mfma_f32_16x16x32_bf16 v[96:99], v[156:159], v[152:155], v[96:99]
  v_mfma_f32_16x16x32_bf16 v[100:103], v[160:163], v[148:151], v[100:103]
  v_mfma_f32_16x16x32_bf16 v[104:107], v[160:163], v[152:155], v[104:107]
  v_mfma_f32_16x16x32_bf16 v[108:111], v[148:151], v[164:167], v[108:111]
  v_mfma_f32_16x16x32_bf16 v[112:115], v[152:155], v[164:167], v[112:115]
  s_nop 7
  v_mul_f32 v92, 0x3eb8aa3b, v92
  v_mul_f32 v93, 0x3eb8aa3b, v93
  v_mul_f32 v94, 0x3eb8aa3b, v94
  v_mul_f32 v95, 0x3eb8aa3b, v95
  v_mul_f32 v96, 0x3eb8aa3b, v96
  v_mul_f32 v97, 0x3eb8aa3b, v97
  v_mul_f32 v98, 0x3eb8aa3b, v98
  v_mul_f32 v99, 0x3eb8aa3b, v99
  v_cvt_pk_bf16_f32 v120, v92, v93
  v_cvt_pk_bf16_f32 v121, v94, v95
  v_cvt_pk_bf16_f32 v122, v96, v97
  v_cvt_pk_bf16_f32 v123, v98, v99
  s_nop 1
  v_permlane16_swap_b32 v120, v122
  v_permlane16_swap_b32 v121, v123
  v_cvt_pk_bf16_f32 v24, v100, v101
  v_cvt_pk_bf16_f32 v25, v102, v103
  v_cvt_pk_bf16_f32 v26, v104, v105
  v_cvt_pk_bf16_f32 v27, v106, v107
  s_nop 1
  v_permlane16_swap_b32 v24, v26
  v_permlane16_swap_b32 v25, v27
  v_cvt_pk_bf16_f32 v28, v108, v109
  v_cvt_pk_bf16_f32 v29, v110, v111
  v_cvt_pk_bf16_f32 v30, v112, v113
  v_cvt_pk_bf16_f32 v31, v114, v115
  s_nop 1
  v_permlane16_swap_b32 v28, v30
  v_permlane16_swap_b32 v29, v31
  s_lshl_b32 s74, s93, 10
  s_add_u32 s74, s74, 1048576
  buffer_store_dwordx4 v[24:27], v2, s[64:67], s74 offen sc1
  s_mul_i32 s74, s93, 1088
  s_add_u32 s74, s74, 3145728
  buffer_store_dwordx4 v[28:31], v248, s[64:67], s74 offen sc1
  s_mov_b32 exec_lo, 0x00010001
  s_mov_b32 exec_hi, 0x00010001
  buffer_store_dwordx4 v[4:7], v249, s[64:67], s74 offen offset:256 sc1
  s_mov_b64 exec, -1
  v_mov_b32 v112, 0xdddd
  v_mov_b32 v115, v250
  v_mov_b32 v20, v2
  s_waitcnt vmcnt(3)
  ds_write_b128 v247, v[4:7]
  ds_write_b128 v243, v[176:179] offset:0
  ds_write_b128 v244, v[180:183] offset:0
  ds_write_b128 v243, v[184:187] offset:1024
  ds_write_b128 v244, v[188:191] offset:1088
  ds_write_b128 v243, v[192:195] offset:2048
  ds_write_b128 v244, v[196:199] offset:2176
  s_waitcnt lgkmcnt(0)
  s_barrier
  v_add_u32 v113, 94208, v20
  v_mov_b32 v252, 0x71800000
  v_mov_b32 v253, 0x7e800000
  s_mov_b32 s84, 0
  s_mov_b32 s95, 436
  ds_read_b128 v[88:91], v113
  s_waitcnt lgkmcnt(0)
  v_mfma_f32_32x32x16_bf16 v[24:39], v[88:91], v[116:119], 0
  s_mov_b32 s68, 0x11ffff
  s_mov_b32 s69, 0x11ffff
  v_mov_b64 v[96:97], 0
  v_mov_b64 v[98:99], 0
  v_mov_b64 v[100:101], 0
  v_mov_b64 v[102:103], 0
  v_mov_b64 v[104:105], 0
  v_mov_b64 v[106:107], 0
  v_mov_b64 v[108:109], 0
  v_mov_b64 v[110:111], 0
  s_nop 3
  s_nop 3
  v_max3_f32 v1, v24, v25, v26
  v_max_f32 v1, v1, v27
  v_max3_f32 v1, v1, v28, v29
  v_max3_f32 v1, v1, v30, v31
  v_max3_f32 v1, v1, v32, v33
  v_max3_f32 v1, v1, v34, v35
  v_max3_f32 v1, v1, v36, v37
  v_max3_f32 v1, v1, v38, v39
  v_mov_b32 v2, v1
  s_nop 1
  v_permlane32_swap_b32 v1, v2
  s_nop 0
  v_max_f32 v1, v1, v2
  v_add_f32 v1, 0x42800000, v1
L_Arun:
  v_sub_f32 v56, 0, v1
  v_sub_f32 v57, 0, v1
  v_sub_f32 v58, 0, v1
  v_sub_f32 v59, 0, v1
  v_sub_f32 v60, 0, v1
  v_sub_f32 v61, 0, v1
  v_sub_f32 v62, 0, v1
  v_sub_f32 v63, 0, v1
  v_sub_f32 v64, 0, v1
  v_sub_f32 v65, 0, v1
  v_sub_f32 v66, 0, v1
  v_sub_f32 v67, 0, v1
  v_sub_f32 v68, 0, v1
  v_sub_f32 v69, 0, v1
  v_sub_f32 v70, 0, v1
  v_sub_f32 v71, 0, v1
  v_add_u32 v113, 94208, v20
  v_mov_b32 v114, v115
  ds_read_b128 v[88:91], v113
  ds_read_b128 v[92:95], v113 offset:1024
  s_mov_b64 exec, s[68:69]
  ds_read_b128 v[96:99], v114 offset:0
  ds_read_b128 v[104:107], v114 offset:544
  s_mov_b64 exec, -1
  v_mov_b64 v[72:73], 0
  v_mov_b64 v[74:75], 0
  v_mov_b64 v[76:77], 0
  v_mov_b64 v[78:79], 0
  v_mov_b64 v[80:81], 0
  v_mov_b64 v[82:83], 0
  v_mov_b64 v[84:85], 0
  v_mov_b64 v[86:87], 0
  v_mov_b64 v[48:49], 0
  v_mov_b64 v[50:51], 0
  v_mov_b64 v[52:53], 0
  v_mov_b64 v[54:55], 0
  v_mov_b64 v[108:109], 0
  v_mov_b64 v[110:111], 0
  s_waitcnt lgkmcnt(3)
  v_mfma_f32_32x32x16_bf16 v[24:39], v[88:91], v[116:119], v[56:71]
  s_mov_b32 s85, 0
  s_nop 7
  s_nop 3
  s_setprio 3
  s_cmp_lg_u32 s84, 0
  s_cbranch_scc1 L_Aloop
  s_mul_i32 s74, s3, 5120
  s_add_u32 s77, s74, 90112
  s_add_u32 s78, s74, 155648
  s_add_u32 s79, s77, 4096
  s_add_u32 s80, s78, 4096
  v_exp_f32 v24, v24
  v_exp_f32 v25, v25
  v_exp_f32 v26, v26
  v_exp_f32 v27, v27
  v_smfmac_f32_32x32x32_bf16 v[72:87], v[108:111], v[48:55], v112
  buffer_load_dwordx4 v[200:203], v20, s[64:67], s77 offen offset:0 sc1
  v_exp_f32 v28, v28
  v_exp_f32 v29, v29
  v_exp_f32 v30, v30
  v_exp_f32 v31, v31
  s_waitcnt lgkmcnt(0)
  v_mfma_f32_32x32x16_bf16 v[40:55], v[92:95], v[116:119], v[56:71]
  ds_read_b128 v[88:91], v113 offset:2048
  s_mov_b64 exec, s[68:69]
  ds_read_b128 v[100:103], v114 offset:1088
  ds_read_b128 v[108:111], v114 offset:1632
  s_mov_b64 exec, -1
  v_exp_f32 v32, v32
  v_exp_f32 v33, v33
  v_exp_f32 v34, v34
  v_exp_f32 v35, v35
  v_smfmac_f32_32x32x32_bf16 v[72:87], v[96:99], v[24:31], v112
  buffer_load_dwordx4 v[204:207], v20, s[64:67], s78 offen offset:0 sc1
  v_exp_f32 v36, v36
  v_exp_f32 v37, v37
  v_exp_f32 v38, v38
  v_exp_f32 v39, v39
  v_exp_f32 v40, v40
  v_exp_f32 v41, v41
  v_exp_f32 v42, v42
  v_exp_f32 v43, v43
  v_smfmac_f32_32x32x32_bf16 v[72:87], v[104:107], v[32:39], v112
  buffer_load_dwordx4 v[208:211], v20, s[64:67], s77 offen offset:1024 sc1
  v_exp_f32 v44, v44
  v_exp_f32 v45, v45
  v_exp_f32 v46, v46
  v_exp_f32 v47, v47
  s_waitcnt lgkmcnt(0)
  v_mfma_f32_32x32x16_bf16 v[24:39], v[88:91], v[116:119], v[56:71]
  ds_read_b128 v[92:95], v113 offset:3072
  s_mov_b64 exec, s[68:69]
  ds_read_b128 v[96:99], v114 offset:2176
  ds_read_b128 v[104:107], v114 offset:2720
  s_mov_b64 exec, -1
  v_exp_f32 v48, v48
  v_exp_f32 v49, v49
  v_exp_f32 v50, v50
  v_exp_f32 v51, v51
  v_smfmac_f32_32x32x32_bf16 v[72:87], v[100:103], v[40:47], v112
  buffer_load_dwordx4 v[212:215], v20, s[64:67], s78 offen offset:1024 sc1
  v_exp_f32 v52, v52
  v_exp_f32 v53, v53
  v_exp_f32 v54, v54
  v_exp_f32 v55, v55
  v_exp_f32 v24, v24
  v_exp_f32 v25, v25
  v_exp_f32 v26, v26
  v_exp_f32 v27, v27
  v_smfmac_f32_32x32x32_bf16 v[72:87], v[108:111], v[48:55], v112
  buffer_load_dwordx4 v[216:219], v20, s[64:67], s77 offen offset:2048 sc1
  v_exp_f32 v28, v28
  v_exp_f32 v29, v29
  v_exp_f32 v30, v30
  v_exp_f32 v31, v31
  s_waitcnt lgkmcnt(0)
  v_mfma_f32_32x32x16_bf16 v[40:55], v[92:95], v[116:119], v[56:71]
  ds_read_b128 v[88:91], v113 offset:4096
  s_mov_b64 exec, s[68:69]
  ds_read_b128 v[100:103], v114 offset:3264
  ds_read_b128 v[108:111], v114 offset:3808
  s_mov_b64 exec, -1
  v_exp_f32 v32, v32
  v_exp_f32 v33, v33
  v_exp_f32 v34, v34
  v_exp_f32 v35, v35
  v_smfmac_f32_32x32x32_bf16 v[72:87], v[96:99], v[24:31], v112
  buffer_load_dwordx4 v[220:223], v20, s[64:67], s78 offen offset:2048 sc1
  v_exp_f32 v36, v36
  v_exp_f32 v37, v37
  v_exp_f32 v38, v38
  v_exp_f32 v39, v39
  v_exp_f32 v40, v40
  v_exp_f32 v41, v41
  v_exp_f32 v42, v42
  v_exp_f32 v43, v43
  v_smfmac_f32_32x32x32_bf16 v[72:87], v[104:107], v[32:39], v112
  buffer_load_dwordx4 v[224:227], v20, s[64:67], s77 offen offset:3072 sc1
  v_exp_f32 v44, v44
  v_exp_f32 v45, v45
  v_exp_f32 v46, v46
  v_exp_f32 v47, v47
  s_waitcnt lgkmcnt(0)
  v_mfma_f32_32x32x16_bf16 v[24:39], v[88:91], v[116:119], v[56:71]
  ds_read_b128 v[92:95], v113 offset:5120
  s_mov_b64 exec, s[68:69]
  ds_read_b128 v[96:99], v114 offset:4352
  ds_read_b128 v[104:107], v114 offset:4896
  s_mov_b64 exec, -1
  v_exp_f32 v48, v48
  v_exp_f32 v49, v49
  v_exp_f32 v50, v50
  v_exp_f32 v51, v51
  v_smfmac_f32_32x32x32_bf16 v[72:87], v[100:103], v[40:47], v112
  buffer_load_dwordx4 v[228:231], v20, s[64:67], s78 offen offset:3072 sc1
  v_exp_f32 v52, v52
  v_exp_f32 v53, v53
  v_exp_f32 v54, v54
  v_exp_f32 v55, v55
  v_exp_f32 v24, v24
  v_exp_f32 v25, v25
  v_exp_f32 v26, v26
  v_exp_f32 v27, v27
  v_smfmac_f32_32x32x32_bf16 v[72:87], v[108:111], v[48:55], v112
  buffer_load_dwordx4 v[232:235], v20, s[64:67], s79 offen offset:0 sc1
  v_exp_f32 v28, v28
  v_exp_f32 v29, v29
  v_exp_f32 v30, v30
  v_exp_f32 v31, v31
  s_waitcnt lgkmcnt(0)
  v_mfma_f32_32x32x16_bf16 v[40:55], v[92:95], v[116:119], v[56:71]
  ds_read_b128 v[88:91], v113 offset:6144
  s_mov_b64 exec, s[68:69]
  ds_read_b128 v[100:103], v114 offset:5440
  ds_read_b128 v[108:111], v114 offset:5984
  s_mov_b64 exec, -1
  v_exp_f32 v32, v32
  v_exp_f32 v33, v33
  v_exp_f32 v34, v34
  v_exp_f32 v35, v35
  v_smfmac_f32_32x32x32_bf16 v[72:87], v[96:99], v[24:31], v112
  buffer_load_dwordx4 v[236:239], v20, s[64:67], s80 offen offset:0 sc1
  v_exp_f32 v36, v36
  v_exp_f32 v37, v37
  v_exp_f32 v38, v38
  v_exp_f32 v39, v39
  v_exp_f32 v40, v40
  v_exp_f32 v41, v41
  v_exp_f32 v42, v42
  v_exp_f32 v43, v43
  v_smfmac_f32_32x32x32_bf16 v[72:87], v[104:107], v[32:39], v112
  s_lshl_b32 s74, s91, 5
  s_add_u32 s74, s74, s92
  s_lshl_b32 s74, s74, 10
  s_add_u32 s74, s74, 8388608
  v_mov_b64 v[240:241], -1
  v_lshrrev_b32 v242, 1, v20
  buffer_store_dwordx2 v[240:241], v242, s[64:67], s74 offen sc1
  buffer_store_dwordx2 v[240:241], v242, s[64:67], s74 offen offset:512 sc1
  v_exp_f32 v44, v44
  v_exp_f32 v45, v45
  v_exp_f32 v46, v46
  v_exp_f32 v47, v47
  s_waitcnt lgkmcnt(0)
  v_mfma_f32_32x32x16_bf16 v[24:39], v[88:91], v[116:119], v[56:71]
  ds_read_b128 v[92:95], v113 offset:7168
  s_mov_b64 exec, s[68:69]
  ds_read_b128 v[96:99], v114 offset:6528
  ds_read_b128 v[104:107], v114 offset:7072
  s_mov_b64 exec, -1
  v_exp_f32 v48, v48
  v_exp_f32 v49, v49
  v_exp_f32 v50, v50
  v_exp_f32 v51, v51
  v_smfmac_f32_32x32x32_bf16 v[72:87], v[100:103], v[40:47], v112
  s_lshl_b32 s74, s70, 1
  s_and_b32 s75, s3, 1
  s_add_u32 s74, s74, s75
  s_lshl_b32 s74, s74, 3
  s_add_u32 s74, s74, s71
  s_lshl_b32 s74, s74, 2
  s_lshr_b32 s75, s3, 1
  s_add_u32 s74, s74, s75
  s_lshl_b32 s74, s74, 10
  s_add_u32 s74, s74, 6291456
  buffer_store_dwordx2 v[240:241], v242, s[64:67], s74 offen sc1
  buffer_store_dwordx2 v[240:241], v242, s[64:67], s74 offen offset:512 sc1
  v_exp_f32 v52, v52
  v_exp_f32 v53, v53
  v_exp_f32 v54, v54
  v_exp_f32 v55, v55
  v_exp_f32 v24, v24
  v_exp_f32 v25, v25
  v_exp_f32 v26, v26
  v_exp_f32 v27, v27
  v_smfmac_f32_32x32x32_bf16 v[72:87], v[108:111], v[48:55], v112
  v_exp_f32 v28, v28
  v_exp_f32 v29, v29
  v_exp_f32 v30, v30
  v_exp_f32 v31, v31
  s_waitcnt lgkmcnt(0)
  v_mfma_f32_32x32x16_bf16 v[40:55], v[92:95], v[116:119], v[56:71]
  ds_read_b128 v[88:91], v113 offset:8192
  s_mov_b64 exec, s[68:69]
  ds_read_b128 v[100:103], v114 offset:7616
  ds_read_b128 v[108:111], v114 offset:8160
  s_mov_b64 exec, -1
  v_exp_f32 v32, v32
  v_exp_f32 v33, v33
  v_exp_f32 v34, v34
  v_exp_f32 v35, v35
  v_smfmac_f32_32x32x32_bf16 v[72:87], v[96:99], v[24:31], v112
  v_exp_f32 v36, v36
  v_exp_f32 v37, v37
  v_exp_f32 v38, v38
  v_exp_f32 v39, v39
  v_exp_f32 v40, v40
  v_exp_f32 v41, v41
  v_exp_f32 v42, v42
  v_exp_f32 v43, v43
  v_smfmac_f32_32x32x32_bf16 v[72:87], v[104:107], v[32:39], v112
  v_exp_f32 v44, v44
  v_exp_f32 v45, v45
  v_exp_f32 v46, v46
  v_exp_f32 v47, v47
  s_waitcnt lgkmcnt(0)
  v_mfma_f32_32x32x16_bf16 v[24:39], v[88:91], v[116:119], v[56:71]
  ds_read_b128 v[92:95], v113 offset:9216
  s_mov_b64 exec, s[68:69]
  ds_read_b128 v[96:99], v114 offset:8704
  ds_read_b128 v[104:107], v114 offset:9248
  s_mov_b64 exec, -1
  v_exp_f32 v48, v48
  v_exp_f32 v49, v49
  v_exp_f32 v50, v50
  v_exp_f32 v51, v51
  v_smfmac_f32_32x32x32_bf16 v[72:87], v[100:103], v[40:47], v112
  v_add_u32 v113, 8192, v113
  v_add_u32 v114, 8704, v114
  v_exp_f32 v52, v52
  v_exp_f32 v53, v53
  v_exp_f32 v54, v54
  v_exp_f32 v55, v55
  s_mov_b32 s85, 1
L_Aloop:
  v_exp_f32 v24, v24
  v_exp_f32 v25, v25
  v_exp_f32 v26, v26
  v_exp_f32 v27, v27
  v_smfmac_f32_32x32x32_bf16 v[72:87], v[108:111], v[48:55], v112
  v_exp_f32 v28, v28
  v_exp_f32 v29, v29
  v_exp_f32 v30, v30
  v_exp_f32 v31, v31
  s_waitcnt lgkmcnt(0)
  v_mfma_f32_32x32x16_bf16 v[40:55], v[92:95], v[116:119], v[56:71]
  ds_read_b128 v[88:91], v113 offset:2048
  s_mov_b64 exec, s[68:69]
  ds_read_b128 v[100:103], v114 offset:1088
  ds_read_b128 v[108:111], v114 offset:1632
  s_mov_b64 exec, -1
  v_exp_f32 v32, v32
  v_exp_f32 v33, v33
  v_exp_f32 v34, v34
  v_exp_f32 v35, v35
  v_smfmac_f32_32x32x32_bf16 v[72:87], v[96:99], v[24:31], v112
  v_exp_f32 v36, v36
  v_exp_f32 v37, v37
  v_exp_f32 v38, v38
  v_exp_f32 v39, v39
  v_exp_f32 v40, v40
  v_exp_f32 v41, v41
  v_exp_f32 v42, v42
  v_exp_f32 v43, v43
  v_smfmac_f32_32x32x32_bf16 v[72:87], v[104:107], v[32:39], v112
  v_exp_f32 v44, v44
  v_exp_f32 v45, v45
  v_exp_f32 v46, v46
  v_exp_f32 v47, v47
  s_waitcnt lgkmcnt(0)
  v_mfma_f32_32x32x16_bf16 v[24:39], v[88:91], v[116:119], v[56:71]
  ds_read_b128 v[92:95], v113 offset:3072
  s_mov_b64 exec, s[68:69]
  ds_read_b128 v[96:99], v114 offset:2176
  ds_read_b128 v[104:107], v114 offset:2720
  s_mov_b64 exec, -1
  v_exp_f32 v48, v48
  v_exp_f32 v49, v49
  v_exp_f32 v50, v50
  v_exp_f32 v51, v51
  v_smfmac_f32_32x32x32_bf16 v[72:87], v[100:103], v[40:47], v112
  v_exp_f32 v52, v52
  v_exp_f32 v53, v53
  v_exp_f32 v54, v54
  v_exp_f32 v55, v55
  v_exp_f32 v24, v24
  v_exp_f32 v25, v25
  v_exp_f32 v26, v26
  v_exp_f32 v27, v27
  v_smfmac_f32_32x32x32_bf16 v[72:87], v[108:111], v[48:55], v112
  v_exp_f32 v28, v28
  v_exp_f32 v29, v29
  v_exp_f32 v30, v30
  v_exp_f32 v31, v31
  s_waitcnt lgkmcnt(0)
  v_mfma_f32_32x32x16_bf16 v[40:55], v[92:95], v[116:119], v[56:71]
  ds_read_b128 v[88:91], v113 offset:4096
  s_mov_b64 exec, s[68:69]
  ds_read_b128 v[100:103], v114 offset:3264
  ds_read_b128 v[108:111], v114 offset:3808
  s_mov_b64 exec, -1
  v_exp_f32 v32, v32
  v_exp_f32 v33, v33
  v_exp_f32 v34, v34
  v_exp_f32 v35, v35
  v_smfmac_f32_32x32x32_bf16 v[72:87], v[96:99], v[24:31], v112
  v_exp_f32 v36, v36
  v_exp_f32 v37, v37
  v_exp_f32 v38, v38
  v_exp_f32 v39, v39
  v_exp_f32 v40, v40
  v_exp_f32 v41, v41
  v_exp_f32 v42, v42
  v_exp_f32 v43, v43
  v_smfmac_f32_32x32x32_bf16 v[72:87], v[104:107], v[32:39], v112
  v_exp_f32 v44, v44
  v_exp_f32 v45, v45
  v_exp_f32 v46, v46
  v_exp_f32 v47, v47
  s_waitcnt lgkmcnt(0)
  v_mfma_f32_32x32x16_bf16 v[24:39], v[88:91], v[116:119], v[56:71]
  ds_read_b128 v[92:95], v113 offset:5120
  s_mov_b64 exec, s[68:69]
  ds_read_b128 v[96:99], v114 offset:4352
  ds_read_b128 v[104:107], v114 offset:4896
  s_mov_b64 exec, -1
  v_exp_f32 v48, v48
  v_exp_f32 v49, v49
  v_exp_f32 v50, v50
  v_exp_f32 v51, v51
  v_smfmac_f32_32x32x32_bf16 v[72:87], v[100:103], v[40:47], v112
  v_exp_f32 v52, v52
  v_exp_f32 v53, v53
  v_exp_f32 v54, v54
  v_exp_f32 v55, v55
  v_exp_f32 v24, v24
  v_exp_f32 v25, v25
  v_exp_f32 v26, v26
  v_exp_f32 v27, v27
  v_smfmac_f32_32x32x32_bf16 v[72:87], v[108:111], v[48:55], v112
  v_exp_f32 v28, v28
  v_exp_f32 v29, v29
  v_exp_f32 v30, v30
  v_exp_f32 v31, v31
  s_waitcnt lgkmcnt(0)
  v_mfma_f32_32x32x16_bf16 v[40:55], v[92:95], v[116:119], v[56:71]
  ds_read_b128 v[88:91], v113 offset:6144
  s_mov_b64 exec, s[68:69]
  ds_read_b128 v[100:103], v114 offset:5440
  ds_read_b128 v[108:111], v114 offset:5984
  s_mov_b64 exec, -1
  v_exp_f32 v32, v32
  v_exp_f32 v33, v33
  v_exp_f32 v34, v34
  v_exp_f32 v35, v35
  v_smfmac_f32_32x32x32_bf16 v[72:87], v[96:99], v[24:31], v112
  v_exp_f32 v36, v36
  v_exp_f32 v37, v37
  v_exp_f32 v38, v38
  v_exp_f32 v39, v39
  v_exp_f32 v40, v40
  v_exp_f32 v41, v41
  v_exp_f32 v42, v42
  v_exp_f32 v43, v43
  v_smfmac_f32_32x32x32_bf16 v[72:87], v[104:107], v[32:39], v112
  v_exp_f32 v44, v44
  v_exp_f32 v45, v45
  v_exp_f32 v46, v46
  v_exp_f32 v47, v47
  s_waitcnt lgkmcnt(0)
  v_mfma_f32_32x32x16_bf16 v[24:39], v[88:91], v[116:119], v[56:71]
  ds_read_b128 v[92:95], v113 offset:7168
  s_mov_b64 exec, s[68:69]
  ds_read_b128 v[96:99], v114 offset:6528
  ds_read_b128 v[104:107], v114 offset:7072
  s_mov_b64 exec, -1
  v_exp_f32 v48, v48
  v_exp_f32 v49, v49
  v_exp_f32 v50, v50
  v_exp_f32 v51, v51
  v_smfmac_f32_32x32x32_bf16 v[72:87], v[100:103], v[40:47], v112
  v_exp_f32 v52, v52
  v_exp_f32 v53, v53
  v_exp_f32 v54, v54
  v_exp_f32 v55, v55
  v_exp_f32 v24, v24
  v_exp_f32 v25, v25
  v_exp_f32 v26, v26
  v_exp_f32 v27, v27
  v_smfmac_f32_32x32x32_bf16 v[72:87], v[108:111], v[48:55], v112
  v_exp_f32 v28, v28
  v_exp_f32 v29, v29
  v_exp_f32 v30, v30
  v_exp_f32 v31, v31
  s_waitcnt lgkmcnt(0)
  v_mfma_f32_32x32x16_bf16 v[40:55], v[92:95], v[116:119], v[56:71]
  ds_read_b128 v[88:91], v113 offset:8192
  s_mov_b64 exec, s[68:69]
  ds_read_b128 v[100:103], v114 offset:7616
  ds_read_b128 v[108:111], v114 offset:8160
  s_mov_b64 exec, -1
  v_exp_f32 v32, v32
  v_exp_f32 v33, v33
  v_exp_f32 v34, v34
  v_exp_f32 v35, v35
  v_smfmac_f32_32x32x32_bf16 v[72:87], v[96:99], v[24:31], v112
  v_exp_f32 v36, v36
  v_exp_f32 v37, v37
  v_exp_f32 v38, v38
  v_exp_f32 v39, v39
  v_exp_f32 v40, v40
  v_exp_f32 v41, v41
  v_exp_f32 v42, v42
  v_exp_f32 v43, v43
  v_smfmac_f32_32x32x32_bf16 v[72:87], v[104:107], v[32:39], v112
  v_exp_f32 v44, v44
  v_exp_f32 v45, v45
  v_exp_f32 v46, v46
  v_exp_f32 v47, v47
  s_waitcnt lgkmcnt(0)
  v_mfma_f32_32x32x16_bf16 v[24:39], v[88:91], v[116:119], v[56:71]
  ds_read_b128 v[92:95], v113 offset:9216
  s_mov_b64 exec, s[68:69]
  ds_read_b128 v[96:99], v114 offset:8704
  ds_read_b128 v[104:107], v114 offset:9248
  s_mov_b64 exec, -1
  v_exp_f32 v48, v48
  v_exp_f32 v49, v49
  v_exp_f32 v50, v50
  v_exp_f32 v51, v51
  v_smfmac_f32_32x32x32_bf16 v[72:87], v[100:103], v[40:47], v112
  v_add_u32 v113, 8192, v113
  v_add_u32 v114, 8704, v114
  v_exp_f32 v52, v52
  v_exp_f32 v53, v53
  v_exp_f32 v54, v54
  v_exp_f32 v55, v55
  s_add_u32 s85, s85, 1
  s_bitcmp1_b32 s95, s85
  s_cbranch_scc0 L_Aloop
  s_cmp_lg_u32 s85, 8
  s_cbranch_scc1 L_side
  s_nop 0
  v_smfmac_f32_32x32x32_bf16 v[72:87], v[108:111], v[48:55], v112
  s_waitcnt lgkmcnt(0)
  s_setprio 0
  s_nop 7
  s_nop 7
  s_nop 1
  v_max3_f32 v1, |v72|, |v73|, |v74|
  v_max3_f32 v1, v1, |v75|, |v76|
  v_max3_f32 v1, v1, |v77|, |v78|
  v_add_f32 v2, v72, v73
  v_max_f32 v1, v1, |v79|
  v_add_f32 v2, v2, v74
  v_add_f32 v2, v2, v75
  v_add_f32 v2, v2, v76
  v_add_f32 v2, v2, v77
  v_add_f32 v2, v2, v78
  v_add_f32 v2, v2, v79
  v_cmp_nlt_f32 vcc, v80, v252
  v_cmp_nlt_f32 s[88:89], v1, v253
  s_or_b64 vcc, vcc, s[88:89]
  v_cmp_u_f32 s[88:89], v2, v2
  s_or_b64 vcc, vcc, s[88:89]
  s_cmp_eq_u32 s84, 0
  s_cselect_b64 vcc, vcc, 0
  s_cmp_lg_u64 vcc, 0
  s_cbranch_scc1 L_fbA
  v_rcp_f32 v1, v80
  s_nop 0
  v_mul_f32 v72, v72, v1
  v_mul_f32 v73, v73, v1
  v_mul_f32 v74, v74, v1
  v_mul_f32 v75, v75, v1
  v_mul_f32 v76, v76, v1
  v_mul_f32 v77, v77, v1
  v_mul_f32 v78, v78, v1
  v_mul_f32 v79, v79, v1
  v_cvt_pk_bf16_f32 v88, v72, v73
  v_cvt_pk_bf16_f32 v89, v74, v75
  v_cvt_pk_bf16_f32 v90, v76, v77
  v_cvt_pk_bf16_f32 v91, v78, v79
  v_min_u32 v88, -2, v88
  v_min_u32 v89, -2, v89
  v_min_u32 v90, -2, v90
  v_min_u32 v91, -2, v91
  s_lshl_b32 s74, s70, 1
  s_and_b32 s75, s3, 1
  s_add_u32 s74, s74, s75
  s_lshl_b32 s74, s74, 3
  s_add_u32 s74, s74, s71
  s_lshl_b32 s74, s74, 2
  s_lshr_b32 s75, s3, 1
  s_add_u32 s74, s74, s75
  s_lshl_b32 s74, s74, 10
  s_add_u32 s74, s74, 6291456
  v_lshlrev_b32 v4, 4, v0
  buffer_store_dwordx4 v[88:91], v4, s[64:67], s74 offen sc1
  v_and_b32 v1, 31, v0
  v_lshrrev_b32 v2, 5, v0
  v_lshlrev_b32 v2, 2, v2
  v_sub_u32 v1, v1, v2
  v_cvt_f32_i32 v1, v1
  v_mov_b32 v2, 0x5d800000
  s_mov_b32 s84, 0
  v_fmaak_f32 v236, v1, v2, 0x5d000000
  v_fmaak_f32 v237, v1, v2, 0xdd000000
  v_fmaak_f32 v238, v1, v2, 0xddc00000
  v_fmaak_f32 v239, v1, v2, 0xde200000
  v_fmaak_f32 v240, v1, v2, 0xdef00000
  v_fmaak_f32 v241, v1, v2, 0xdf080000
  v_fmaak_f32 v242, v1, v2, 0xdf180000
  v_fmaak_f32 v243, v1, v2, 0xdf280000
  v_fmaak_f32 v244, v1, v2, 0xdf780000
  v_fmaak_f32 v245, v1, v2, 0xdf840000
  v_fmaak_f32 v246, v1, v2, 0xdf8c0000
  v_fmaak_f32 v247, v1, v2, 0xdf940000
  v_fmaak_f32 v248, v1, v2, 0xdfbc0000
  v_fmaak_f32 v249, v1, v2, 0xdfc40000
  v_fmaak_f32 v250, v1, v2, 0xdfcc0000
  v_fmaak_f32 v251, v1, v2, 0xdfd40000
  v_min_f32 v24, 0, v236
  v_min_f32 v25, 0, v237
  v_min_f32 v26, 0, v238
  v_min_f32 v27, 0, v239
  v_min_f32 v28, 0, v240
  v_min_f32 v29, 0, v241
  v_min_f32 v30, 0, v242
  v_min_f32 v31, 0, v243
  v_min_f32 v32, 0, v244
  v_min_f32 v33, 0, v245
  v_min_f32 v34, 0, v246
  v_min_f32 v35, 0, v247
  v_min_f32 v36, 0, v248
  v_min_f32 v37, 0, v249
  v_min_f32 v38, 0, v250
  v_min_f32 v39, 0, v251
  s_waitcnt vmcnt(1)
  v_mfma_f32_32x32x16_bf16 v[24:39], v[128:131], v[120:123], v[24:39]
  v_and_b32 v1, 1, v23
  v_lshlrev_b32 v1, 2, v1
  v_xor_b32 v1, v1, v22
  v_lshlrev_b32 v1, 4, v1
  v_lshl_add_u32 v5, v21, 10, v1
  s_lshl_b32 s74, s3, 16
  s_lshl_b32 s75, s71, 7
  s_add_u32 s74, s74, s75
  v_add_u32 v5, s74, v5
  s_lshl_b32 s94, s3, 13
  s_nop 3
  v_max3_f32 v1, v24, v25, v26
  v_max_f32 v1, v1, v27
  v_max3_f32 v1, v1, v28, v29
  v_max3_f32 v1, v1, v30, v31
  v_max3_f32 v1, v1, v32, v33
  v_max3_f32 v1, v1, v34, v35
  v_max3_f32 v1, v1, v36, v37
  v_max3_f32 v1, v1, v38, v39
  v_mov_b32 v2, v1
  s_nop 1
  v_permlane32_swap_b32 v1, v2
  s_nop 0
  v_max_f32 v1, v1, v2
  v_add_f32 v6, 0x42800000, v1
  s_barrier
  s_setprio 1
L_Brun:
  v_sub_f32 v6, 0, v6
  v_mov_b32 v7, v6
  v_pk_add_f32 v[24:25], v[24:25], v[6:7]
  v_pk_add_f32 v[26:27], v[26:27], v[6:7]
  v_pk_add_f32 v[28:29], v[28:29], v[6:7]
  v_pk_add_f32 v[30:31], v[30:31], v[6:7]
  v_pk_add_f32 v[32:33], v[32:33], v[6:7]
  v_pk_add_f32 v[34:35], v[34:35], v[6:7]
  v_pk_add_f32 v[36:37], v[36:37], v[6:7]
  v_pk_add_f32 v[38:39], v[38:39], v[6:7]
  v_mov_b64 v[72:73], 0
  v_mov_b64 v[74:75], 0
  v_mov_b64 v[76:77], 0
  v_mov_b64 v[78:79], 0
  v_mov_b64 v[80:81], 0
  v_mov_b64 v[82:83], 0
  v_mov_b64 v[84:85], 0
  v_mov_b64 v[86:87], 0
  v_mov_b64 v[56:57], v[6:7]
  v_mov_b64 v[58:59], v[6:7]
  v_mov_b64 v[60:61], v[6:7]
  v_mov_b64 v[62:63], v[6:7]
  v_mov_b64 v[64:65], v[6:7]
  v_mov_b64 v[66:67], v[6:7]
  v_mov_b64 v[68:69], v[6:7]
  v_mov_b64 v[70:71], v[6:7]
  v_exp_f32 v24, v24
  v_exp_f32 v25, v25
  v_exp_f32 v26, v26
  v_exp_f32 v27, v27
  v_exp_f32 v28, v28
  v_exp_f32 v29, v29
  v_exp_f32 v30, v30
  v_exp_f32 v31, v31
  v_mfma_f32_32x32x16_bf16 v[40:55], v[132:135], v[120:123], v[56:71]
  v_exp_f32 v32, v32
  v_exp_f32 v33, v33
  v_exp_f32 v34, v34
  v_exp_f32 v35, v35
  v_smfmac_f32_32x32x32_bf16 v[72:87], v[164:167], v[24:31], v112
  v_exp_f32 v36, v36
  v_exp_f32 v37, v37
  v_exp_f32 v38, v38
  v_exp_f32 v39, v39
  s_cmp_lg_u32 s84, 0
  s_cbranch_scc1 L_ac3
  s_add_u32 m0, s94, 0
  s_mov_b32 s74, 0
  buffer_load_dwordx4 v5, s[48:51], s74 offen lds
  s_add_u32 m0, s94, 1024
  s_mov_b32 s74, 8192
  buffer_load_dwordx4 v5, s[48:51], s74 offen lds
L_ac3:
  s_cmp_eq_u32 s86, 0
  s_cbranch_scc1 L_Bx0
  s_nop 1
  v_exp_f32 v40, v40
  v_exp_f32 v41, v41
  v_exp_f32 v42, v42
  v_exp_f32 v43, v43
  v_smfmac_f32_32x32x32_bf16 v[72:87], v[168:171], v[32:39], v112
  v_exp_f32 v44, v44
  v_exp_f32 v45, v45
  v_exp_f32 v46, v46
  v_exp_f32 v47, v47
  v_mfma_f32_32x32x16_bf16 v[24:39], v[136:139], v[120:123], v[56:71]
  v_exp_f32 v48, v48
  v_exp_f32 v49, v49
  v_exp_f32 v50, v50
  v_exp_f32 v51, v51
  v_smfmac_f32_32x32x32_bf16 v[72:87], v[172:175], v[40:47], v112
  v_exp_f32 v52, v52
  v_exp_f32 v53, v53
  v_exp_f32 v54, v54
  v_exp_f32 v55, v55
  s_cmp_lg_u32 s84, 0
  s_cbranch_scc1 L_ac4
  s_add_u32 m0, s94, 2048
  s_mov_b32 s74, 16384
  buffer_load_dwordx4 v5, s[48:51], s74 offen lds
  s_add_u32 m0, s94, 3072
  s_mov_b32 s74, 24576
  buffer_load_dwordx4 v5, s[48:51], s74 offen lds
L_ac4:
  s_cmp_eq_u32 s86, 1
  s_cbranch_scc1 L_Bx1
  s_nop 1
  v_exp_f32 v24, v24
  v_exp_f32 v25, v25
  v_exp_f32 v26, v26
  v_exp_f32 v27, v27
  v_smfmac_f32_32x32x32_bf16 v[72:87], v[176:179], v[48:55], v112
  v_exp_f32 v28, v28
  v_exp_f32 v29, v29
  v_exp_f32 v30, v30
  v_exp_f32 v31, v31
  v_mfma_f32_32x32x16_bf16 v[40:55], v[140:143], v[120:123], v[56:71]
  v_exp_f32 v32, v32
  v_exp_f32 v33, v33
  v_exp_f32 v34, v34
  v_exp_f32 v35, v35
  v_smfmac_f32_32x32x32_bf16 v[72:87], v[180:183], v[24:31], v112
  v_exp_f32 v36, v36
  v_exp_f32 v37, v37
  v_exp_f32 v38, v38
  v_exp_f32 v39, v39
  s_cmp_lg_u32 s84, 0
  s_cbranch_scc1 L_ac5
  s_add_u32 m0, s94, 4096
  s_mov_b32 s74, 32768
  buffer_load_dwordx4 v5, s[48:51], s74 offen lds
  s_add_u32 m0, s94, 5120
  s_mov_b32 s74, 40960
  buffer_load_dwordx4 v5, s[48:51], s74 offen lds
L_ac5:
  s_cmp_eq_u32 s86, 2
  s_cbranch_scc1 L_Bx2
  s_nop 1
  v_exp_f32 v40, v40
  v_exp_f32 v41, v41
  v_exp_f32 v42, v42
  v_exp_f32 v43, v43
  v_smfmac_f32_32x32x32_bf16 v[72:87], v[184:187], v[32:39], v112
  v_exp_f32 v44, v44
  v_exp_f32 v45, v45
  v_exp_f32 v46, v46
  v_exp_f32 v47, v47
  v_mfma_f32_32x32x16_bf16 v[24:39], v[144:147], v[120:123], v[56:71]
  v_exp_f32 v48, v48
  v_exp_f32 v49, v49
  v_exp_f32 v50, v50
  v_exp_f32 v51, v51
  v_smfmac_f32_32x32x32_bf16 v[72:87], v[188:191], v[40:47], v112
  v_exp_f32 v52, v52
  v_exp_f32 v53, v53
  v_exp_f32 v54, v54
  v_exp_f32 v55, v55
  s_cmp_lg_u32 s84, 0
  s_cbranch_scc1 L_ac6
  s_add_u32 m0, s94, 6144
  s_mov_b32 s74, 49152
  buffer_load_dwordx4 v5, s[48:51], s74 offen lds
  s_add_u32 m0, s94, 7168
  s_mov_b32 s74, 57344
  buffer_load_dwordx4 v5, s[48:51], s74 offen lds
L_ac6:
  s_cmp_eq_u32 s86, 3
  s_cbranch_scc1 L_Bx3
  s_nop 1
  v_exp_f32 v24, v24
  v_exp_f32 v25, v25
  v_exp_f32 v26, v26
  v_exp_f32 v27, v27
  v_smfmac_f32_32x32x32_bf16 v[72:87], v[192:195], v[48:55], v112
  v_exp_f32 v28, v28
  v_exp_f32 v29, v29
  v_exp_f32 v30, v30
  v_exp_f32 v31, v31
  v_mfma_f32_32x32x16_bf16 v[40:55], v[148:151], v[120:123], v[56:71]
  v_exp_f32 v32, v32
  v_exp_f32 v33, v33
  v_exp_f32 v34, v34
  v_exp_f32 v35, v35
  v_smfmac_f32_32x32x32_bf16 v[72:87], v[196:199], v[24:31], v112
  v_exp_f32 v36, v36
  v_exp_f32 v37, v37
  v_exp_f32 v38, v38
  v_exp_f32 v39, v39
  s_cmp_lg_u32 s84, 0
  s_cbranch_scc1 L_ac7
  s_add_u32 m0, s94, 69632
  s_mov_b32 s74, 0
  buffer_load_dwordx4 v5, s[52:55], s74 offen lds
  s_add_u32 m0, s94, 70656
  s_mov_b32 s74, 8192
  buffer_load_dwordx4 v5, s[52:55], s74 offen lds
L_ac7:
  s_cmp_eq_u32 s86, 4
  s_cbranch_scc1 L_Bx4
  s_nop 1
  v_exp_f32 v40, v40
  v_exp_f32 v41, v41
  v_exp_f32 v42, v42
  v_exp_f32 v43, v43
  v_smfmac_f32_32x32x32_bf16 v[72:87], v[200:203], v[32:39], v112
  v_exp_f32 v44, v44
  v_exp_f32 v45, v45
  v_exp_f32 v46, v46
  v_exp_f32 v47, v47
  v_mfma_f32_32x32x16_bf16 v[24:39], v[152:155], v[120:123], v[56:71]
  v_exp_f32 v48, v48
  v_exp_f32 v49, v49
  v_exp_f32 v50, v50
  v_exp_f32 v51, v51
  v_smfmac_f32_32x32x32_bf16 v[72:87], v[204:207], v[40:47], v112
  v_exp_f32 v52, v52
  v_exp_f32 v53, v53
  v_exp_f32 v54, v54
  v_exp_f32 v55, v55
  s_cmp_lg_u32 s84, 0
  s_cbranch_scc1 L_ac8
  s_add_u32 m0, s94, 71680
  s_mov_b32 s74, 16384
  buffer_load_dwordx4 v5, s[52:55], s74 offen lds
  s_add_u32 m0, s94, 72704
  s_mov_b32 s74, 24576
  buffer_load_dwordx4 v5, s[52:55], s74 offen lds
  s_setprio 0
L_ac8:
  s_cmp_eq_u32 s86, 5
  s_cbranch_scc1 L_Bx5
  s_nop 1
  v_exp_f32 v24, v24
  v_exp_f32 v25, v25
  v_exp_f32 v26, v26
  v_exp_f32 v27, v27
  v_smfmac_f32_32x32x32_bf16 v[72:87], v[208:211], v[48:55], v112
  v_exp_f32 v28, v28
  v_exp_f32 v29, v29
  v_exp_f32 v30, v30
  v_exp_f32 v31, v31
  v_mfma_f32_32x32x16_bf16 v[40:55], v[156:159], v[120:123], v[56:71]
  v_exp_f32 v32, v32
  v_exp_f32 v33, v33
  v_exp_f32 v34, v34
  v_exp_f32 v35, v35
  v_smfmac_f32_32x32x32_bf16 v[72:87], v[212:215], v[24:31], v112
  v_exp_f32 v36, v36
  v_exp_f32 v37, v37
  v_exp_f32 v38, v38
  v_exp_f32 v39, v39
  v_min_f32 v56, -v236, v6
  v_min_f32 v57, -v237, v6
  v_min_f32 v58, -v238, v6
  v_min_f32 v59, -v239, v6
  v_min_f32 v60, -v240, v6
  v_min_f32 v61, -v241, v6
  v_min_f32 v62, -v242, v6
  v_min_f32 v63, -v243, v6
  v_min_f32 v64, -v244, v6
  v_min_f32 v65, -v245, v6
  v_min_f32 v66, -v246, v6
  v_min_f32 v67, -v247, v6
  v_min_f32 v68, -v248, v6
  v_min_f32 v69, -v249, v6
  v_min_f32 v70, -v250, v6
  v_min_f32 v71, -v251, v6
  s_cmp_lg_u32 s84, 0
  s_cbranch_scc1 L_ac9
  s_lshl_b32 s74, s70, 1
  s_and_b32 s75, s3, 1
  s_add_u32 s74, s74, s75
  s_lshl_b32 s74, s74, 2
  s_lshr_b32 s75, s3, 1
  s_add_u32 s74, s74, s75
  s_lshl_b32 s74, s74, 13
  s_add_u32 s77, s74, 6291456
  s_add_u32 s78, s77, 4096
  buffer_load_dwordx4 v[88:91], v4, s[64:67], s77 offen offset:0 sc1
  buffer_load_dwordx4 v[92:95], v4, s[64:67], s77 offen offset:1024 sc1
  buffer_load_dwordx4 v[96:99], v4, s[64:67], s77 offen offset:2048 sc1
  buffer_load_dwordx4 v[100:103], v4, s[64:67], s77 offen offset:3072 sc1
L_ac9:
  s_cmp_eq_u32 s86, 6
  s_cbranch_scc1 L_Bx6
  s_nop 1
  v_exp_f32 v40, v40
  v_exp_f32 v41, v41
  v_exp_f32 v42, v42
  v_exp_f32 v43, v43
  v_smfmac_f32_32x32x32_bf16 v[72:87], v[216:219], v[32:39], v112
  v_exp_f32 v44, v44
  v_exp_f32 v45, v45
  v_exp_f32 v46, v46
  v_exp_f32 v47, v47
  v_mfma_f32_32x32x16_bf16 v[24:39], v[160:163], v[120:123], v[56:71]
  v_exp_f32 v48, v48
  v_exp_f32 v49, v49
  v_exp_f32 v50, v50
  v_exp_f32 v51, v51
  v_smfmac_f32_32x32x32_bf16 v[72:87], v[220:223], v[40:47], v112
  v_exp_f32 v52, v52
  v_exp_f32 v53, v53
  v_exp_f32 v54, v54
  v_exp_f32 v55, v55
  s_cmp_lg_u32 s84, 0
  s_cbranch_scc1 L_ac10
  buffer_load_dwordx4 v[104:107], v4, s[64:67], s78 offen offset:0 sc1
  buffer_load_dwordx4 v[108:111], v4, s[64:67], s78 offen offset:1024 sc1
  buffer_load_dwordx4 v[116:119], v4, s[64:67], s78 offen offset:2048 sc1
  buffer_load_dwordx4 v[124:127], v4, s[64:67], s78 offen offset:3072 sc1
L_ac10:
  s_cmp_eq_u32 s86, 7
  s_cbranch_scc1 L_Bx7
  s_nop 1
  v_exp_f32 v24, v24
  v_exp_f32 v25, v25
  v_exp_f32 v26, v26
  v_exp_f32 v27, v27
  v_smfmac_f32_32x32x32_bf16 v[72:87], v[224:227], v[48:55], v112
  v_exp_f32 v28, v28
  v_exp_f32 v29, v29
  v_exp_f32 v30, v30
  v_exp_f32 v31, v31
  v_exp_f32 v32, v32
  v_exp_f32 v33, v33
  v_exp_f32 v34, v34
  v_exp_f32 v35, v35
  v_smfmac_f32_32x32x32_bf16 v[72:87], v[228:231], v[24:31], v112
  v_exp_f32 v36, v36
  v_exp_f32 v37, v37
  v_exp_f32 v38, v38
  v_exp_f32 v39, v39
  s_cmp_lg_u32 s84, 0
  s_cbranch_scc1 L_ac11
L_ac11:
  s_nop 1
  v_smfmac_f32_32x32x32_bf16 v[72:87], v[232:235], v[32:39], v112
L_Bdone:
  s_setprio 0
  v_bfe_u32 v1, v0, 2, 2
  v_lshrrev_b32 v2, 5, v0
  v_lshl_add_u32 v3, v2, 2, v1
  v_lshlrev_b32 v3, 7, v3
  v_lshrrev_b32 v1, 1, v1
  v_lshl_add_u32 v3, v1, 6, v3
  v_and_b32 v1, 1, v23
  v_lshl_add_u32 v3, v1, 5, v3
  v_and_b32 v1, 3, v0
  v_lshl_add_u32 v3, v1, 3, v3
  s_lshr_b32 s74, s3, 1
  s_mul_i32 s75, s74, 16416
  v_xor_b32 v7, s75, v3
  v_xor_b32 v8, 64, v7
  v_add_u32 v9, 69632, v7
  v_add_u32 v10, 69632, v8
  s_lshl_b32 s74, s74, 5
  s_lshl_b32 s75, s71, 7
  s_add_u32 s74, s74, s75
  s_and_b32 s75, s3, 1
  s_lshl_b32 s75, s75, 16
  s_add_u32 s74, s74, s75
  v_and_b32 v1, 31, v0
  v_lshlrev_b32 v1, 11, v1
  v_lshl_add_u32 v1, v2, 4, v1
  v_add_u32 v15, s74, v1
  s_mul_i32 s74, s3, 6144
  v_add_u32 v14, s74, v4
  s_xor_b32 s74, s3, 2
  s_mul_i32 s74, s74, 6144
  s_add_u32 s74, s74, 0
  v_add_u32 v11, s74, v4
  s_xor_b32 s74, s3, 4
  s_mul_i32 s74, s74, 6144
  s_add_u32 s74, s74, 2048
  v_add_u32 v12, s74, v4
  s_xor_b32 s74, s3, 6
  s_mul_i32 s74, s74, 6144
  s_add_u32 s74, s74, 4096
  v_add_u32 v13, s74, v4
  s_nop 1
  v_max3_f32 v1, |v72|, |v73|, |v74|
  v_max3_f32 v1, v1, |v75|, |v76|
  v_max3_f32 v1, v1, |v77|, |v78|
  v_add_f32 v2, v72, v73
  v_max_f32 v1, v1, |v79|
  v_add_f32 v2, v2, v74
  v_add_f32 v2, v2, v75
  v_add_f32 v2, v2, v76
  v_add_f32 v2, v2, v77
  v_add_f32 v2, v2, v78
  v_add_f32 v2, v2, v79
  v_cmp_nlt_f32 vcc, v80, v252
  v_cmp_nlt_f32 s[88:89], v1, v253
  s_or_b64 vcc, vcc, s[88:89]
  v_cmp_u_f32 s[88:89], v2, v2
  s_or_b64 vcc, vcc, s[88:89]
  s_cmp_eq_u32 s84, 0
  s_cselect_b64 vcc, vcc, 0
  s_cmp_lg_u64 vcc, 0
  s_cbranch_scc1 L_fbB
  v_rcp_f32 v1, v80
  s_nop 0
  v_mul_f32 v72, v72, v1
  v_mul_f32 v73, v73, v1
  v_mul_f32 v74, v74, v1
  v_mul_f32 v75, v75, v1
  v_mul_f32 v76, v76, v1
  v_mul_f32 v77, v77, v1
  v_mul_f32 v78, v78, v1
  v_mul_f32 v79, v79, v1
  v_cvt_pk_bf16_f32 v72, v72, v73
  v_cvt_pk_bf16_f32 v73, v74, v75
  v_cvt_pk_bf16_f32 v74, v76, v77
  v_cvt_pk_bf16_f32 v75, v78, v79
  v_min_u32 v72, -2, v72
  v_min_u32 v73, -2, v73
  v_min_u32 v74, -2, v74
  v_min_u32 v75, -2, v75
  s_lshl_b32 s74, s91, 5
  s_add_u32 s74, s74, s92
  s_lshl_b32 s74, s74, 10
  s_add_u32 s74, s74, 8388608
  buffer_store_dwordx4 v[72:75], v4, s[64:67], s74 offen sc1
  s_waitcnt vmcnt(9)
  s_barrier
  s_mov_b32 s87, 0x40000
  ds_read_b64_tr_b16 v[56:57], v7 offset:0
  ds_read_b64_tr_b16 v[58:59], v7 offset:1024
  ds_read_b64_tr_b16 v[60:61], v8 offset:0
  ds_read_b64_tr_b16 v[62:63], v8 offset:1024
  ds_read_b64_tr_b16 v[64:65], v7 offset:2048
  ds_read_b64_tr_b16 v[66:67], v7 offset:3072
  ds_read_b64_tr_b16 v[68:69], v8 offset:2048
  ds_read_b64_tr_b16 v[70:71], v8 offset:3072
  s_waitcnt vmcnt(8) lgkmcnt(4)
  v_max3_u32 v1, v88, v89, v90
  v_max_u32 v1, v1, v91
  v_cmp_eq_u32 vcc, -1, v1
  s_cbranch_vccnz L_ar0
L_ag0:
  v_mfma_f32_32x32x16_bf16 v[24:39], v[56:59], v[88:91], 0
  v_mfma_f32_32x32x16_bf16 v[40:55], v[60:63], v[88:91], 0
  s_add_u32 m0, s94, 73728
  s_mov_b32 s74, 32768
  buffer_load_dwordx4 v5, s[52:55], s74 offen lds
  ds_read_b64_tr_b16 v[56:57], v7 offset:4096
  ds_read_b64_tr_b16 v[58:59], v7 offset:5120
  ds_read_b64_tr_b16 v[60:61], v8 offset:4096
  ds_read_b64_tr_b16 v[62:63], v8 offset:5120
  s_waitcnt vmcnt(8) lgkmcnt(4)
  v_max3_u32 v1, v92, v93, v94
  v_max_u32 v1, v1, v95
  v_cmp_eq_u32 vcc, -1, v1
  s_cbranch_vccnz L_ar1
L_ag1:
  v_mfma_f32_32x32x16_bf16 v[24:39], v[64:67], v[92:95], v[24:39]
  v_mfma_f32_32x32x16_bf16 v[40:55], v[68:71], v[92:95], v[40:55]
  s_add_u32 m0, s94, 74752
  s_mov_b32 s74, 40960
  buffer_load_dwordx4 v5, s[52:55], s74 offen lds
  ds_read_b64_tr_b16 v[64:65], v7 offset:6144
  ds_read_b64_tr_b16 v[66:67], v7 offset:7168
  ds_read_b64_tr_b16 v[68:69], v8 offset:6144
  ds_read_b64_tr_b16 v[70:71], v8 offset:7168
  s_waitcnt vmcnt(8) lgkmcnt(4)
  v_max3_u32 v1, v96, v97, v98
  v_max_u32 v1, v1, v99
  v_cmp_eq_u32 vcc, -1, v1
  s_cbranch_vccnz L_ar2
L_ag2:
  v_mfma_f32_32x32x16_bf16 v[24:39], v[56:59], v[96:99], v[24:39]
  v_mfma_f32_32x32x16_bf16 v[40:55], v[60:63], v[96:99], v[40:55]
  s_add_u32 m0, s94, 75776
  s_mov_b32 s74, 49152
  buffer_load_dwordx4 v5, s[52:55], s74 offen lds
  ds_read_b64_tr_b16 v[56:57], v7 offset:8192
  ds_read_b64_tr_b16 v[58:59], v7 offset:9216
  ds_read_b64_tr_b16 v[60:61], v8 offset:8192
  ds_read_b64_tr_b16 v[62:63], v8 offset:9216
  s_waitcnt vmcnt(8) lgkmcnt(4)
  v_max3_u32 v1, v100, v101, v102
  v_max_u32 v1, v1, v103
  v_cmp_eq_u32 vcc, -1, v1
  s_cbranch_vccnz L_ar3
L_ag3:
  v_mfma_f32_32x32x16_bf16 v[24:39], v[64:67], v[100:103], v[24:39]
  v_mfma_f32_32x32x16_bf16 v[40:55], v[68:71], v[100:103], v[40:55]
  s_add_u32 m0, s94, 76800
  s_mov_b32 s74, 57344
  buffer_load_dwordx4 v5, s[52:55], s74 offen lds
  ds_read_b64_tr_b16 v[64:65], v7 offset:10240
  ds_read_b64_tr_b16 v[66:67], v7 offset:11264
  ds_read_b64_tr_b16 v[68:69], v8 offset:10240
  ds_read_b64_tr_b16 v[70:71], v8 offset:11264
  s_waitcnt vmcnt(8) lgkmcnt(4)
  v_max3_u32 v1, v104, v105, v106
  v_max_u32 v1, v1, v107
  v_cmp_eq_u32 vcc, -1, v1
  s_cbranch_vccnz L_ar4
L_ag4:
  v_mfma_f32_32x32x16_bf16 v[24:39], v[56:59], v[104:107], v[24:39]
  v_mfma_f32_32x32x16_bf16 v[40:55], v[60:63], v[104:107], v[40:55]
  ds_read_b64_tr_b16 v[56:57], v7 offset:12288
  ds_read_b64_tr_b16 v[58:59], v7 offset:13312
  ds_read_b64_tr_b16 v[60:61], v8 offset:12288
  ds_read_b64_tr_b16 v[62:63], v8 offset:13312
  s_waitcnt vmcnt(7) lgkmcnt(4)
  v_max3_u32 v1, v108, v109, v110
  v_max_u32 v1, v1, v111
  v_cmp_eq_u32 vcc, -1, v1
  s_cbranch_vccnz L_ar5
L_ag5:
  v_mfma_f32_32x32x16_bf16 v[24:39], v[64:67], v[108:111], v[24:39]
  v_mfma_f32_32x32x16_bf16 v[40:55], v[68:71], v[108:111], v[40:55]
  ds_read_b64_tr_b16 v[64:65], v7 offset:14336
  ds_read_b64_tr_b16 v[66:67], v7 offset:15360
  ds_read_b64_tr_b16 v[68:69], v8 offset:14336
  ds_read_b64_tr_b16 v[70:71], v8 offset:15360
  s_waitcnt vmcnt(6) lgkmcnt(4)
  v_max3_u32 v1, v116, v117, v118
  v_max_u32 v1, v1, v119
  v_cmp_eq_u32 vcc, -1, v1
  s_cbranch_vccnz L_ar6
L_ag6:
  v_mfma_f32_32x32x16_bf16 v[24:39], v[56:59], v[116:119], v[24:39]
  v_mfma_f32_32x32x16_bf16 v[40:55], v[60:63], v[116:119], v[40:55]
  s_waitcnt vmcnt(5) lgkmcnt(0)
  v_max3_u32 v1, v124, v125, v126
  v_max_u32 v1, v1, v127
  v_cmp_eq_u32 vcc, -1, v1
  s_cbranch_vccnz L_ar7
L_ag7:
  v_mfma_f32_32x32x16_bf16 v[24:39], v[64:67], v[124:127], v[24:39]
  v_mfma_f32_32x32x16_bf16 v[40:55], v[68:71], v[124:127], v[40:55]
  s_barrier
  s_mov_b32 s87, 0x40000
  s_lshl_b32 s74, s83, 1
  s_and_b32 s75, s3, 1
  s_add_u32 s74, s74, s75
  s_lshl_b32 s74, s74, 2
  s_lshr_b32 s75, s3, 1
  s_add_u32 s74, s74, s75
  s_lshl_b32 s74, s74, 13
  s_add_u32 s77, s74, 8388608
  s_add_u32 s78, s77, 4096
  buffer_load_dwordx4 v[160:163], v4, s[64:67], s77 offen offset:0 sc1
  buffer_load_dwordx4 v[164:167], v4, s[64:67], s77 offen offset:1024 sc1
  buffer_load_dwordx4 v[168:171], v4, s[64:67], s77 offen offset:2048 sc1
  s_nop 7
  s_nop 3
  ds_write_b128 v11, v[32:35] offset:0
  ds_write_b128 v11, v[36:39] offset:1024
  ds_write_b128 v12, v[40:43] offset:0
  ds_write_b128 v12, v[44:47] offset:1024
  ds_write_b128 v13, v[48:51] offset:0
  ds_write_b128 v13, v[52:55] offset:1024
  buffer_load_dwordx4 v[172:175], v4, s[64:67], s77 offen offset:3072 sc1
  buffer_load_dwordx4 v[176:179], v4, s[64:67], s78 offen offset:0 sc1
  s_waitcnt lgkmcnt(0)
  s_waitcnt vmcnt(5)
  s_barrier
  ds_read_b128 v[192:195], v14 offset:0
  ds_read_b128 v[196:199], v14 offset:1024
  ds_read_b128 v[200:203], v14 offset:2048
  ds_read_b128 v[204:207], v14 offset:3072
  ds_read_b128 v[208:211], v14 offset:4096
  ds_read_b128 v[212:215], v14 offset:5120
  buffer_load_dwordx4 v[180:183], v4, s[64:67], s78 offen offset:1024 sc1
  buffer_load_dwordx4 v[184:187], v4, s[64:67], s78 offen offset:2048 sc1
  buffer_load_dwordx4 v[188:191], v4, s[64:67], s78 offen offset:3072 sc1
  s_waitcnt lgkmcnt(4)
  v_pk_add_f32 v[24:25], v[24:25], v[192:193]
  v_pk_add_f32 v[26:27], v[26:27], v[194:195]
  v_pk_add_f32 v[28:29], v[28:29], v[196:197]
  v_pk_add_f32 v[30:31], v[30:31], v[198:199]
  s_waitcnt lgkmcnt(2)
  v_pk_add_f32 v[24:25], v[24:25], v[200:201]
  v_pk_add_f32 v[26:27], v[26:27], v[202:203]
  v_pk_add_f32 v[28:29], v[28:29], v[204:205]
  v_pk_add_f32 v[30:31], v[30:31], v[206:207]
  s_waitcnt lgkmcnt(0)
  v_pk_add_f32 v[24:25], v[24:25], v[208:209]
  v_pk_add_f32 v[26:27], v[26:27], v[210:211]
  v_pk_add_f32 v[28:29], v[28:29], v[212:213]
  v_pk_add_f32 v[30:31], v[30:31], v[214:215]
  v_cvt_pk_bf16_f32 v224, v24, v25
  v_cvt_pk_bf16_f32 v225, v26, v27
  v_cvt_pk_bf16_f32 v226, v28, v29
  v_cvt_pk_bf16_f32 v227, v30, v31
  s_nop 1
  v_permlane32_swap_b32 v224, v226
  v_permlane32_swap_b32 v225, v227
  s_lshl_b32 s74, s70, 17
  s_add_u32 s74, s74, 0
  buffer_store_dwordx4 v[224:227], v15, s[56:59], s74 offen nt
  ds_read_b64_tr_b16 v[56:57], v9 offset:0
  ds_read_b64_tr_b16 v[58:59], v9 offset:1024
  ds_read_b64_tr_b16 v[60:61], v10 offset:0
  ds_read_b64_tr_b16 v[62:63], v10 offset:1024
  ds_read_b64_tr_b16 v[64:65], v9 offset:2048
  ds_read_b64_tr_b16 v[66:67], v9 offset:3072
  ds_read_b64_tr_b16 v[68:69], v10 offset:2048
  ds_read_b64_tr_b16 v[70:71], v10 offset:3072
  s_waitcnt vmcnt(8) lgkmcnt(4)
L_oc0:
  v_max3_u32 v1, v160, v161, v162
  v_max_u32 v1, v1, v163
  v_cmp_eq_u32 vcc, -1, v1
  s_cbranch_vccnz L_or0
L_og0:
  v_mfma_f32_32x32x16_bf16 v[24:39], v[56:59], v[160:163], 0
  v_mfma_f32_32x32x16_bf16 v[40:55], v[60:63], v[160:163], 0
  ds_read_b64_tr_b16 v[56:57], v9 offset:4096
  ds_read_b64_tr_b16 v[58:59], v9 offset:5120
  ds_read_b64_tr_b16 v[60:61], v10 offset:4096
  ds_read_b64_tr_b16 v[62:63], v10 offset:5120
  s_waitcnt vmcnt(7) lgkmcnt(4)
L_oc1:
  v_max3_u32 v1, v164, v165, v166
  v_max_u32 v1, v1, v167
  v_cmp_eq_u32 vcc, -1, v1
  s_cbranch_vccnz L_or1
L_og1:
  v_mfma_f32_32x32x16_bf16 v[24:39], v[64:67], v[164:167], v[24:39]
  v_mfma_f32_32x32x16_bf16 v[40:55], v[68:71], v[164:167], v[40:55]
  ds_read_b64_tr_b16 v[64:65], v9 offset:6144
  ds_read_b64_tr_b16 v[66:67], v9 offset:7168
  ds_read_b64_tr_b16 v[68:69], v10 offset:6144
  ds_read_b64_tr_b16 v[70:71], v10 offset:7168
  s_waitcnt vmcnt(6) lgkmcnt(4)
L_oc2:
  v_max3_u32 v1, v168, v169, v170
  v_max_u32 v1, v1, v171
  v_cmp_eq_u32 vcc, -1, v1
  s_cbranch_vccnz L_or2
L_og2:
  v_mfma_f32_32x32x16_bf16 v[24:39], v[56:59], v[168:171], v[24:39]
  v_mfma_f32_32x32x16_bf16 v[40:55], v[60:63], v[168:171], v[40:55]
  ds_read_b64_tr_b16 v[56:57], v9 offset:8192
  ds_read_b64_tr_b16 v[58:59], v9 offset:9216
  ds_read_b64_tr_b16 v[60:61], v10 offset:8192
  ds_read_b64_tr_b16 v[62:63], v10 offset:9216
  s_waitcnt vmcnt(5) lgkmcnt(4)
L_oc3:
  v_max3_u32 v1, v172, v173, v174
  v_max_u32 v1, v1, v175
  v_cmp_eq_u32 vcc, -1, v1
  s_cbranch_vccnz L_or3
L_og3:
  v_mfma_f32_32x32x16_bf16 v[24:39], v[64:67], v[172:175], v[24:39]
  v_mfma_f32_32x32x16_bf16 v[40:55], v[68:71], v[172:175], v[40:55]
  ds_read_b64_tr_b16 v[64:65], v9 offset:10240
  ds_read_b64_tr_b16 v[66:67], v9 offset:11264
  ds_read_b64_tr_b16 v[68:69], v10 offset:10240
  ds_read_b64_tr_b16 v[70:71], v10 offset:11264
  s_waitcnt vmcnt(4) lgkmcnt(4)
L_oc4:
  v_max3_u32 v1, v176, v177, v178
  v_max_u32 v1, v1, v179
  v_cmp_eq_u32 vcc, -1, v1
  s_cbranch_vccnz L_or4
L_og4:
  v_mfma_f32_32x32x16_bf16 v[24:39], v[56:59], v[176:179], v[24:39]
  v_mfma_f32_32x32x16_bf16 v[40:55], v[60:63], v[176:179], v[40:55]
  ds_read_b64_tr_b16 v[56:57], v9 offset:12288
  ds_read_b64_tr_b16 v[58:59], v9 offset:13312
  ds_read_b64_tr_b16 v[60:61], v10 offset:12288
  ds_read_b64_tr_b16 v[62:63], v10 offset:13312
  s_waitcnt vmcnt(3) lgkmcnt(4)
L_oc5:
  v_max3_u32 v1, v180, v181, v182
  v_max_u32 v1, v1, v183
  v_cmp_eq_u32 vcc, -1, v1
  s_cbranch_vccnz L_or5
L_og5:
  v_mfma_f32_32x32x16_bf16 v[24:39], v[64:67], v[180:183], v[24:39]
  v_mfma_f32_32x32x16_bf16 v[40:55], v[68:71], v[180:183], v[40:55]
  ds_read_b64_tr_b16 v[64:65], v9 offset:14336
  ds_read_b64_tr_b16 v[66:67], v9 offset:15360
  ds_read_b64_tr_b16 v[68:69], v10 offset:14336
  ds_read_b64_tr_b16 v[70:71], v10 offset:15360
  s_waitcnt vmcnt(2) lgkmcnt(4)
L_oc6:
  v_max3_u32 v1, v184, v185, v186
  v_max_u32 v1, v1, v187
  v_cmp_eq_u32 vcc, -1, v1
  s_cbranch_vccnz L_or6
L_og6:
  v_mfma_f32_32x32x16_bf16 v[24:39], v[56:59], v[184:187], v[24:39]
  v_mfma_f32_32x32x16_bf16 v[40:55], v[60:63], v[184:187], v[40:55]
  s_waitcnt vmcnt(1) lgkmcnt(0)
L_oc7:
  v_max3_u32 v1, v188, v189, v190
  v_max_u32 v1, v1, v191
  v_cmp_eq_u32 vcc, -1, v1
  s_cbranch_vccnz L_or7
L_og7:
  v_mfma_f32_32x32x16_bf16 v[24:39], v[64:67], v[188:191], v[24:39]
  v_mfma_f32_32x32x16_bf16 v[40:55], v[68:71], v[188:191], v[40:55]
  s_nop 7
  s_nop 3
  ds_write_b128 v11, v[32:35] offset:0
  ds_write_b128 v11, v[36:39] offset:1024
  ds_write_b128 v12, v[40:43] offset:0
  ds_write_b128 v12, v[44:47] offset:1024
  ds_write_b128 v13, v[48:51] offset:0
  ds_write_b128 v13, v[52:55] offset:1024
  s_waitcnt lgkmcnt(0)
  s_barrier
  ds_read_b128 v[192:195], v14 offset:0
  ds_read_b128 v[196:199], v14 offset:1024
  ds_read_b128 v[200:203], v14 offset:2048
  ds_read_b128 v[204:207], v14 offset:3072
  ds_read_b128 v[208:211], v14 offset:4096
  ds_read_b128 v[212:215], v14 offset:5120
  s_waitcnt lgkmcnt(4)
  v_pk_add_f32 v[24:25], v[24:25], v[192:193]
  v_pk_add_f32 v[26:27], v[26:27], v[194:195]
  v_pk_add_f32 v[28:29], v[28:29], v[196:197]
  v_pk_add_f32 v[30:31], v[30:31], v[198:199]
  s_waitcnt lgkmcnt(2)
  v_pk_add_f32 v[24:25], v[24:25], v[200:201]
  v_pk_add_f32 v[26:27], v[26:27], v[202:203]
  v_pk_add_f32 v[28:29], v[28:29], v[204:205]
  v_pk_add_f32 v[30:31], v[30:31], v[206:207]
  s_waitcnt lgkmcnt(0)
  v_pk_add_f32 v[24:25], v[24:25], v[208:209]
  v_pk_add_f32 v[26:27], v[26:27], v[210:211]
  v_pk_add_f32 v[28:29], v[28:29], v[212:213]
  v_pk_add_f32 v[30:31], v[30:31], v[214:215]
  v_cvt_pk_bf16_f32 v228, v24, v25
  v_cvt_pk_bf16_f32 v229, v26, v27
  v_cvt_pk_bf16_f32 v230, v28, v29
  v_cvt_pk_bf16_f32 v231, v30, v31
  s_nop 1
  v_permlane32_swap_b32 v228, v230
  v_permlane32_swap_b32 v229, v231
  s_lshl_b32 s74, s83, 17
  s_add_u32 s74, s74, 1024
  buffer_store_dwordx4 v[228:231], v15, s[56:59], s74 offen
L_end:
  s_endpgm
L_side:
  s_cmp_lg_u32 s85, 2
  s_cbranch_scc1 L_side2
  s_waitcnt vmcnt(0)
  ds_write_b128 v251, v[4:7]
  ds_write_b128 v245, v[200:203] offset:0
  ds_write_b128 v246, v[204:207] offset:0
  ds_write_b128 v245, v[208:211] offset:1024
  ds_write_b128 v246, v[212:215] offset:1088
  ds_write_b128 v245, v[216:219] offset:2048
  ds_write_b128 v246, v[220:223] offset:2176
  ds_write_b128 v245, v[224:227] offset:3072
  ds_write_b128 v246, v[228:231] offset:3264
  ds_write_b128 v245, v[232:235] offset:4096
  ds_write_b128 v246, v[236:239] offset:4352
  s_waitcnt lgkmcnt(0)
  s_barrier
  s_cmp_lg_u32 s3, 7
  s_cbranch_scc1 L_Aloop
  s_and_b32 s74, s2, 7
  s_add_u32 s74, s74, 8
  s_lshl_b32 s74, s74, 8
  v_mov_b32 v1, 1
  v_mov_b32 v254, 0
  s_mov_b64 exec, 1
  buffer_atomic_add v1, v254, s[64:67], s74 offen sc1
  s_mov_b64 exec, -1
  s_branch L_Aloop
L_side2:
  s_cmp_lg_u32 s85, 7
  s_cbranch_scc1 L_side3
  s_setprio 0
  s_branch L_Aloop
L_side3:
  s_cmp_eq_u32 s85, 5
  s_cbranch_scc1 L_side4
  v_lshlrev_b32 v2, 8, v22
  v_add_u32 v2, 2048, v2
  buffer_load_dword v3, v2, s[64:67], 0 offen sc1
  s_lshl_b32 s74, s3, 16
  s_lshl_b32 s75, s71, 7
  s_add_u32 s74, s74, s75
  v_lshlrev_b32 v4, 10, v0
  buffer_load_dword v5, v4, s[48:51], s74 offen
  buffer_load_dword v6, v4, s[52:55], s74 offen
  s_sub_u32 s74, s93, 8
  s_lshl_b32 s75, s74, 10
  s_add_u32 s77, s75, 1048576
  s_add_u32 s78, s77, 4096
  s_add_u32 s79, s77, 8192
  s_mul_i32 s75, s74, 1088
  s_add_u32 s80, s75, 3145728
  s_add_u32 s81, s80, 4352
  s_add_u32 s82, s80, 8704
  s_min_u32 s86, s91, 8
  s_branch L_Aloop
L_side4:
  s_mov_b32 s87, 0x40000
  s_branch L_pw12
L_pl12:
  buffer_load_dword v3, v2, s[64:67], 0 offen sc1
L_pw12:
  s_waitcnt vmcnt(0)
  v_cmp_ne_u32 vcc, 32, v3
  s_sub_u32 s87, s87, 1
  s_cbranch_scc1 L_pd12
  s_cbranch_vccnz L_pl12
L_pd12:
  v_lshlrev_b32 v4, 4, v0
  s_setprio 2
  v_exp_f32 v24, v24
  v_exp_f32 v25, v25
  v_exp_f32 v26, v26
  v_exp_f32 v27, v27
  v_smfmac_f32_32x32x32_bf16 v[72:87], v[108:111], v[48:55], v112
  buffer_load_dwordx4 v[128:131], v4, s[64:67], s79 offen offset:0 sc1
  v_exp_f32 v28, v28
  v_exp_f32 v29, v29
  v_exp_f32 v30, v30
  v_exp_f32 v31, v31
  s_waitcnt lgkmcnt(0)
  v_mfma_f32_32x32x16_bf16 v[40:55], v[92:95], v[116:119], v[56:71]
  ds_read_b128 v[88:91], v113 offset:2048
  s_mov_b64 exec, s[68:69]
  ds_read_b128 v[100:103], v114 offset:1088
  ds_read_b128 v[108:111], v114 offset:1632
  s_mov_b64 exec, -1
  v_exp_f32 v32, v32
  v_exp_f32 v33, v33
  v_exp_f32 v34, v34
  v_exp_f32 v35, v35
  v_smfmac_f32_32x32x32_bf16 v[72:87], v[96:99], v[24:31], v112
  buffer_load_dwordx4 v[164:167], v115, s[64:67], s82 offen offset:0 sc1
  v_exp_f32 v36, v36
  v_exp_f32 v37, v37
  v_exp_f32 v38, v38
  v_exp_f32 v39, v39
  v_exp_f32 v40, v40
  v_exp_f32 v41, v41
  v_exp_f32 v42, v42
  v_exp_f32 v43, v43
  v_smfmac_f32_32x32x32_bf16 v[72:87], v[104:107], v[32:39], v112
  buffer_load_dwordx4 v[168:171], v115, s[64:67], s82 offen offset:544 sc1
  v_exp_f32 v44, v44
  v_exp_f32 v45, v45
  v_exp_f32 v46, v46
  v_exp_f32 v47, v47
  s_waitcnt lgkmcnt(0)
  v_mfma_f32_32x32x16_bf16 v[24:39], v[88:91], v[116:119], v[56:71]
  ds_read_b128 v[92:95], v113 offset:3072
  s_mov_b64 exec, s[68:69]
  ds_read_b128 v[96:99], v114 offset:2176
  ds_read_b128 v[104:107], v114 offset:2720
  s_mov_b64 exec, -1
  v_exp_f32 v48, v48
  v_exp_f32 v49, v49
  v_exp_f32 v50, v50
  v_exp_f32 v51, v51
  v_smfmac_f32_32x32x32_bf16 v[72:87], v[100:103], v[40:47], v112
  buffer_load_dwordx4 v[132:135], v4, s[64:67], s78 offen offset:3072 sc1
  v_exp_f32 v52, v52
  v_exp_f32 v53, v53
  v_exp_f32 v54, v54
  v_exp_f32 v55, v55
  v_exp_f32 v24, v24
  v_exp_f32 v25, v25
  v_exp_f32 v26, v26
  v_exp_f32 v27, v27
  v_smfmac_f32_32x32x32_bf16 v[72:87], v[108:111], v[48:55], v112
  buffer_load_dwordx4 v[172:175], v115, s[64:67], s81 offen offset:3264 sc1
  v_exp_f32 v28, v28
  v_exp_f32 v29, v29
  v_exp_f32 v30, v30
  v_exp_f32 v31, v31
  s_waitcnt lgkmcnt(0)
  v_mfma_f32_32x32x16_bf16 v[40:55], v[92:95], v[116:119], v[56:71]
  ds_read_b128 v[88:91], v113 offset:4096
  s_mov_b64 exec, s[68:69]
  ds_read_b128 v[100:103], v114 offset:3264
  ds_read_b128 v[108:111], v114 offset:3808
  s_mov_b64 exec, -1
  v_exp_f32 v32, v32
  v_exp_f32 v33, v33
  v_exp_f32 v34, v34
  v_exp_f32 v35, v35
  v_smfmac_f32_32x32x32_bf16 v[72:87], v[96:99], v[24:31], v112
  buffer_load_dwordx4 v[176:179], v115, s[64:67], s81 offen offset:3808 sc1
  v_exp_f32 v36, v36
  v_exp_f32 v37, v37
  v_exp_f32 v38, v38
  v_exp_f32 v39, v39
  v_exp_f32 v40, v40
  v_exp_f32 v41, v41
  v_exp_f32 v42, v42
  v_exp_f32 v43, v43
  v_smfmac_f32_32x32x32_bf16 v[72:87], v[104:107], v[32:39], v112
  buffer_load_dwordx4 v[136:139], v4, s[64:67], s78 offen offset:2048 sc1
  v_exp_f32 v44, v44
  v_exp_f32 v45, v45
  v_exp_f32 v46, v46
  v_exp_f32 v47, v47
  s_waitcnt lgkmcnt(0)
  v_mfma_f32_32x32x16_bf16 v[24:39], v[88:91], v[116:119], v[56:71]
  ds_read_b128 v[92:95], v113 offset:5120
  s_mov_b64 exec, s[68:69]
  ds_read_b128 v[96:99], v114 offset:4352
  ds_read_b128 v[104:107], v114 offset:4896
  s_mov_b64 exec, -1
  v_exp_f32 v48, v48
  v_exp_f32 v49, v49
  v_exp_f32 v50, v50
  v_exp_f32 v51, v51
  v_smfmac_f32_32x32x32_bf16 v[72:87], v[100:103], v[40:47], v112
  buffer_load_dwordx4 v[180:183], v115, s[64:67], s81 offen offset:2176 sc1
  v_exp_f32 v52, v52
  v_exp_f32 v53, v53
  v_exp_f32 v54, v54
  v_exp_f32 v55, v55
  v_exp_f32 v24, v24
  v_exp_f32 v25, v25
  v_exp_f32 v26, v26
  v_exp_f32 v27, v27
  v_smfmac_f32_32x32x32_bf16 v[72:87], v[108:111], v[48:55], v112
  buffer_load_dwordx4 v[184:187], v115, s[64:67], s81 offen offset:2720 sc1
  v_exp_f32 v28, v28
  v_exp_f32 v29, v29
  v_exp_f32 v30, v30
  v_exp_f32 v31, v31
  s_waitcnt lgkmcnt(0)
  v_mfma_f32_32x32x16_bf16 v[40:55], v[92:95], v[116:119], v[56:71]
  ds_read_b128 v[88:91], v113 offset:6144
  s_mov_b64 exec, s[68:69]
  ds_read_b128 v[100:103], v114 offset:5440
  ds_read_b128 v[108:111], v114 offset:5984
  s_mov_b64 exec, -1
  v_exp_f32 v32, v32
  v_exp_f32 v33, v33
  v_exp_f32 v34, v34
  v_exp_f32 v35, v35
  v_smfmac_f32_32x32x32_bf16 v[72:87], v[96:99], v[24:31], v112
  buffer_load_dwordx4 v[140:143], v4, s[64:67], s78 offen offset:1024 sc1
  v_exp_f32 v36, v36
  v_exp_f32 v37, v37
  v_exp_f32 v38, v38
  v_exp_f32 v39, v39
  v_exp_f32 v40, v40
  v_exp_f32 v41, v41
  v_exp_f32 v42, v42
  v_exp_f32 v43, v43
  v_smfmac_f32_32x32x32_bf16 v[72:87], v[104:107], v[32:39], v112
  buffer_load_dwordx4 v[188:191], v115, s[64:67], s81 offen offset:1088 sc1
  v_exp_f32 v44, v44
  v_exp_f32 v45, v45
  v_exp_f32 v46, v46
  v_exp_f32 v47, v47
  s_waitcnt lgkmcnt(0)
  v_mfma_f32_32x32x16_bf16 v[24:39], v[88:91], v[116:119], v[56:71]
  ds_read_b128 v[92:95], v113 offset:7168
  s_mov_b64 exec, s[68:69]
  ds_read_b128 v[96:99], v114 offset:6528
  ds_read_b128 v[104:107], v114 offset:7072
  s_mov_b64 exec, -1
  v_exp_f32 v48, v48
  v_exp_f32 v49, v49
  v_exp_f32 v50, v50
  v_exp_f32 v51, v51
  v_smfmac_f32_32x32x32_bf16 v[72:87], v[100:103], v[40:47], v112
  buffer_load_dwordx4 v[192:195], v115, s[64:67], s81 offen offset:1632 sc1
  v_exp_f32 v52, v52
  v_exp_f32 v53, v53
  v_exp_f32 v54, v54
  v_exp_f32 v55, v55
  v_exp_f32 v24, v24
  v_exp_f32 v25, v25
  v_exp_f32 v26, v26
  v_exp_f32 v27, v27
  v_smfmac_f32_32x32x32_bf16 v[72:87], v[108:111], v[48:55], v112
  buffer_load_dwordx4 v[144:147], v4, s[64:67], s78 offen offset:0 sc1
  v_exp_f32 v28, v28
  v_exp_f32 v29, v29
  v_exp_f32 v30, v30
  v_exp_f32 v31, v31
  s_waitcnt lgkmcnt(0)
  v_mfma_f32_32x32x16_bf16 v[40:55], v[92:95], v[116:119], v[56:71]
  ds_read_b128 v[88:91], v113 offset:8192
  s_mov_b64 exec, s[68:69]
  ds_read_b128 v[100:103], v114 offset:7616
  ds_read_b128 v[108:111], v114 offset:8160
  s_mov_b64 exec, -1
  v_exp_f32 v32, v32
  v_exp_f32 v33, v33
  v_exp_f32 v34, v34
  v_exp_f32 v35, v35
  v_smfmac_f32_32x32x32_bf16 v[72:87], v[96:99], v[24:31], v112
  buffer_load_dwordx4 v[196:199], v115, s[64:67], s81 offen offset:0 sc1
  v_exp_f32 v36, v36
  v_exp_f32 v37, v37
  v_exp_f32 v38, v38
  v_exp_f32 v39, v39
  v_exp_f32 v40, v40
  v_exp_f32 v41, v41
  v_exp_f32 v42, v42
  v_exp_f32 v43, v43
  v_smfmac_f32_32x32x32_bf16 v[72:87], v[104:107], v[32:39], v112
  buffer_load_dwordx4 v[200:203], v115, s[64:67], s81 offen offset:544 sc1
  v_exp_f32 v44, v44
  v_exp_f32 v45, v45
  v_exp_f32 v46, v46
  v_exp_f32 v47, v47
  s_waitcnt lgkmcnt(0)
  v_mfma_f32_32x32x16_bf16 v[24:39], v[88:91], v[116:119], v[56:71]
  ds_read_b128 v[92:95], v113 offset:9216
  s_mov_b64 exec, s[68:69]
  ds_read_b128 v[96:99], v114 offset:8704
  ds_read_b128 v[104:107], v114 offset:9248
  s_mov_b64 exec, -1
  v_exp_f32 v48, v48
  v_exp_f32 v49, v49
  v_exp_f32 v50, v50
  v_exp_f32 v51, v51
  v_smfmac_f32_32x32x32_bf16 v[72:87], v[100:103], v[40:47], v112
  buffer_load_dwordx4 v[148:151], v4, s[64:67], s77 offen offset:3072 sc1
  v_exp_f32 v52, v52
  v_exp_f32 v53, v53
  v_exp_f32 v54, v54
  v_exp_f32 v55, v55
  v_exp_f32 v24, v24
  v_exp_f32 v25, v25
  v_exp_f32 v26, v26
  v_exp_f32 v27, v27
  v_smfmac_f32_32x32x32_bf16 v[72:87], v[108:111], v[48:55], v112
  buffer_load_dwordx4 v[204:207], v115, s[64:67], s80 offen offset:3264 sc1
  v_exp_f32 v28, v28
  v_exp_f32 v29, v29
  v_exp_f32 v30, v30
  v_exp_f32 v31, v31
  s_waitcnt lgkmcnt(0)
  v_mfma_f32_32x32x16_bf16 v[40:55], v[92:95], v[116:119], v[56:71]
  ds_read_b128 v[88:91], v113 offset:10240
  s_mov_b64 exec, s[68:69]
  ds_read_b128 v[100:103], v114 offset:9792
  ds_read_b128 v[108:111], v114 offset:10336
  s_mov_b64 exec, -1
  v_exp_f32 v32, v32
  v_exp_f32 v33, v33
  v_exp_f32 v34, v34
  v_exp_f32 v35, v35
  v_smfmac_f32_32x32x32_bf16 v[72:87], v[96:99], v[24:31], v112
  buffer_load_dwordx4 v[208:211], v115, s[64:67], s80 offen offset:3808 sc1
  v_exp_f32 v36, v36
  v_exp_f32 v37, v37
  v_exp_f32 v38, v38
  v_exp_f32 v39, v39
  v_exp_f32 v40, v40
  v_exp_f32 v41, v41
  v_exp_f32 v42, v42
  v_exp_f32 v43, v43
  v_smfmac_f32_32x32x32_bf16 v[72:87], v[104:107], v[32:39], v112
  buffer_load_dwordx4 v[152:155], v4, s[64:67], s77 offen offset:2048 sc1
  v_exp_f32 v44, v44
  v_exp_f32 v45, v45
  v_exp_f32 v46, v46
  v_exp_f32 v47, v47
  s_waitcnt lgkmcnt(0)
  v_mfma_f32_32x32x16_bf16 v[24:39], v[88:91], v[116:119], v[56:71]
  ds_read_b128 v[92:95], v113 offset:11264
  s_mov_b64 exec, s[68:69]
  ds_read_b128 v[96:99], v114 offset:10880
  ds_read_b128 v[104:107], v114 offset:11424
  s_mov_b64 exec, -1
  v_exp_f32 v48, v48
  v_exp_f32 v49, v49
  v_exp_f32 v50, v50
  v_exp_f32 v51, v51
  v_smfmac_f32_32x32x32_bf16 v[72:87], v[100:103], v[40:47], v112
  buffer_load_dwordx4 v[212:215], v115, s[64:67], s80 offen offset:2176 sc1
  v_exp_f32 v52, v52
  v_exp_f32 v53, v53
  v_exp_f32 v54, v54
  v_exp_f32 v55, v55
  v_exp_f32 v24, v24
  v_exp_f32 v25, v25
  v_exp_f32 v26, v26
  v_exp_f32 v27, v27
  v_smfmac_f32_32x32x32_bf16 v[72:87], v[108:111], v[48:55], v112
  buffer_load_dwordx4 v[216:219], v115, s[64:67], s80 offen offset:2720 sc1
  v_exp_f32 v28, v28
  v_exp_f32 v29, v29
  v_exp_f32 v30, v30
  v_exp_f32 v31, v31
  s_waitcnt lgkmcnt(0)
  v_mfma_f32_32x32x16_bf16 v[40:55], v[92:95], v[116:119], v[56:71]
  ds_read_b128 v[88:91], v113 offset:12288
  s_mov_b64 exec, s[68:69]
  ds_read_b128 v[100:103], v114 offset:11968
  ds_read_b128 v[108:111], v114 offset:12512
  s_mov_b64 exec, -1
  v_exp_f32 v32, v32
  v_exp_f32 v33, v33
  v_exp_f32 v34, v34
  v_exp_f32 v35, v35
  v_smfmac_f32_32x32x32_bf16 v[72:87], v[96:99], v[24:31], v112
  buffer_load_dwordx4 v[156:159], v4, s[64:67], s77 offen offset:1024 sc1
  v_exp_f32 v36, v36
  v_exp_f32 v37, v37
  v_exp_f32 v38, v38
  v_exp_f32 v39, v39
  v_exp_f32 v40, v40
  v_exp_f32 v41, v41
  v_exp_f32 v42, v42
  v_exp_f32 v43, v43
  v_smfmac_f32_32x32x32_bf16 v[72:87], v[104:107], v[32:39], v112
  buffer_load_dwordx4 v[220:223], v115, s[64:67], s80 offen offset:1088 sc1
  v_exp_f32 v44, v44
  v_exp_f32 v45, v45
  v_exp_f32 v46, v46
  v_exp_f32 v47, v47
  s_waitcnt lgkmcnt(0)
  v_mfma_f32_32x32x16_bf16 v[24:39], v[88:91], v[116:119], v[56:71]
  ds_read_b128 v[92:95], v113 offset:13312
  s_mov_b64 exec, s[68:69]
  ds_read_b128 v[96:99], v114 offset:13056
  ds_read_b128 v[104:107], v114 offset:13600
  s_mov_b64 exec, -1
  v_exp_f32 v48, v48
  v_exp_f32 v49, v49
  v_exp_f32 v50, v50
  v_exp_f32 v51, v51
  v_smfmac_f32_32x32x32_bf16 v[72:87], v[100:103], v[40:47], v112
  buffer_load_dwordx4 v[224:227], v115, s[64:67], s80 offen offset:1632 sc1
  v_exp_f32 v52, v52
  v_exp_f32 v53, v53
  v_exp_f32 v54, v54
  v_exp_f32 v55, v55
  v_exp_f32 v24, v24
  v_exp_f32 v25, v25
  v_exp_f32 v26, v26
  v_exp_f32 v27, v27
  v_smfmac_f32_32x32x32_bf16 v[72:87], v[108:111], v[48:55], v112
  buffer_load_dwordx4 v[160:163], v4, s[64:67], s77 offen offset:0 sc1
  v_exp_f32 v28, v28
  v_exp_f32 v29, v29
  v_exp_f32 v30, v30
  v_exp_f32 v31, v31
  s_waitcnt lgkmcnt(0)
  v_mfma_f32_32x32x16_bf16 v[40:55], v[92:95], v[116:119], v[56:71]
  ds_read_b128 v[88:91], v113 offset:14336
  s_mov_b64 exec, s[68:69]
  ds_read_b128 v[100:103], v114 offset:14144
  ds_read_b128 v[108:111], v114 offset:14688
  s_mov_b64 exec, -1
  v_exp_f32 v32, v32
  v_exp_f32 v33, v33
  v_exp_f32 v34, v34
  v_exp_f32 v35, v35
  v_smfmac_f32_32x32x32_bf16 v[72:87], v[96:99], v[24:31], v112
  buffer_load_dwordx4 v[228:231], v115, s[64:67], s80 offen offset:0 sc1
  v_exp_f32 v36, v36
  v_exp_f32 v37, v37
  v_exp_f32 v38, v38
  v_exp_f32 v39, v39
  v_exp_f32 v40, v40
  v_exp_f32 v41, v41
  v_exp_f32 v42, v42
  v_exp_f32 v43, v43
  v_smfmac_f32_32x32x32_bf16 v[72:87], v[104:107], v[32:39], v112
  buffer_load_dwordx4 v[232:235], v115, s[64:67], s80 offen offset:544 sc1
  v_exp_f32 v44, v44
  v_exp_f32 v45, v45
  v_exp_f32 v46, v46
  v_exp_f32 v47, v47
  s_waitcnt lgkmcnt(0)
  v_mfma_f32_32x32x16_bf16 v[24:39], v[88:91], v[116:119], v[56:71]
  ds_read_b128 v[92:95], v113 offset:15360
  s_mov_b64 exec, s[68:69]
  ds_read_b128 v[96:99], v114 offset:15232
  ds_read_b128 v[104:107], v114 offset:15776
  s_mov_b64 exec, -1
  v_exp_f32 v48, v48
  v_exp_f32 v49, v49
  v_exp_f32 v50, v50
  v_exp_f32 v51, v51
  v_smfmac_f32_32x32x32_bf16 v[72:87], v[100:103], v[40:47], v112
  v_exp_f32 v52, v52
  v_exp_f32 v53, v53
  v_exp_f32 v54, v54
  v_exp_f32 v55, v55
  v_exp_f32 v24, v24
  v_exp_f32 v25, v25
  v_exp_f32 v26, v26
  v_exp_f32 v27, v27
  v_smfmac_f32_32x32x32_bf16 v[72:87], v[108:111], v[48:55], v112
  v_exp_f32 v28, v28
  v_exp_f32 v29, v29
  v_exp_f32 v30, v30
  v_exp_f32 v31, v31
  s_waitcnt lgkmcnt(0)
  v_mfma_f32_32x32x16_bf16 v[40:55], v[92:95], v[116:119], v[56:71]
  ds_read_b128 v[88:91], v113 offset:16384
  s_mov_b64 exec, s[68:69]
  ds_read_b128 v[100:103], v114 offset:16320
  ds_read_b128 v[108:111], v114 offset:16864
  s_mov_b64 exec, -1
  v_exp_f32 v32, v32
  v_exp_f32 v33, v33
  v_exp_f32 v34, v34
  v_exp_f32 v35, v35
  v_smfmac_f32_32x32x32_bf16 v[72:87], v[96:99], v[24:31], v112
  v_exp_f32 v36, v36
  v_exp_f32 v37, v37
  v_exp_f32 v38, v38
  v_exp_f32 v39, v39
  v_exp_f32 v40, v40
  v_exp_f32 v41, v41
  v_exp_f32 v42, v42
  v_exp_f32 v43, v43
  v_smfmac_f32_32x32x32_bf16 v[72:87], v[104:107], v[32:39], v112
  v_exp_f32 v44, v44
  v_exp_f32 v45, v45
  v_exp_f32 v46, v46
  v_exp_f32 v47, v47
  s_waitcnt lgkmcnt(0)
  v_mfma_f32_32x32x16_bf16 v[24:39], v[88:91], v[116:119], v[56:71]
  ds_read_b128 v[92:95], v113 offset:17408
  s_mov_b64 exec, s[68:69]
  ds_read_b128 v[96:99], v114 offset:17408
  ds_read_b128 v[104:107], v114 offset:17952
  s_mov_b64 exec, -1
  v_exp_f32 v48, v48
  v_exp_f32 v49, v49
  v_exp_f32 v50, v50
  v_exp_f32 v51, v51
  v_smfmac_f32_32x32x32_bf16 v[72:87], v[100:103], v[40:47], v112
  v_add_u32 v113, 16384, v113
  v_add_u32 v114, 17408, v114
  v_exp_f32 v52, v52
  v_exp_f32 v53, v53
  v_exp_f32 v54, v54
  v_exp_f32 v55, v55
  s_setprio 0
  s_mov_b32 s85, 7
  s_branch L_Aloop
L_Bx0:
  s_nop 1
  v_smfmac_f32_32x32x32_bf16 v[72:87], v[168:171], v[32:39], v112
  s_cmp_lg_u32 s84, 0
  s_cbranch_scc1 L_ac13
  s_add_u32 m0, s94, 2048
  s_mov_b32 s74, 16384
  buffer_load_dwordx4 v5, s[48:51], s74 offen lds
  s_add_u32 m0, s94, 3072
  s_mov_b32 s74, 24576
  buffer_load_dwordx4 v5, s[48:51], s74 offen lds
  s_add_u32 m0, s94, 4096
  s_mov_b32 s74, 32768
  buffer_load_dwordx4 v5, s[48:51], s74 offen lds
  s_add_u32 m0, s94, 5120
  s_mov_b32 s74, 40960
  buffer_load_dwordx4 v5, s[48:51], s74 offen lds
  s_add_u32 m0, s94, 6144
  s_mov_b32 s74, 49152
  buffer_load_dwordx4 v5, s[48:51], s74 offen lds
  s_add_u32 m0, s94, 7168
  s_mov_b32 s74, 57344
  buffer_load_dwordx4 v5, s[48:51], s74 offen lds
  s_add_u32 m0, s94, 69632
  s_mov_b32 s74, 0
  buffer_load_dwordx4 v5, s[52:55], s74 offen lds
  s_add_u32 m0, s94, 70656
  s_mov_b32 s74, 8192
  buffer_load_dwordx4 v5, s[52:55], s74 offen lds
  s_add_u32 m0, s94, 71680
  s_mov_b32 s74, 16384
  buffer_load_dwordx4 v5, s[52:55], s74 offen lds
  s_add_u32 m0, s94, 72704
  s_mov_b32 s74, 24576
  buffer_load_dwordx4 v5, s[52:55], s74 offen lds
  s_lshl_b32 s74, s70, 1
  s_and_b32 s75, s3, 1
  s_add_u32 s74, s74, s75
  s_lshl_b32 s74, s74, 2
  s_lshr_b32 s75, s3, 1
  s_add_u32 s74, s74, s75
  s_lshl_b32 s74, s74, 13
  s_add_u32 s77, s74, 6291456
  s_add_u32 s78, s77, 4096
  buffer_load_dwordx4 v[88:91], v4, s[64:67], s77 offen offset:0 sc1
  buffer_load_dwordx4 v[92:95], v4, s[64:67], s77 offen offset:1024 sc1
  buffer_load_dwordx4 v[96:99], v4, s[64:67], s77 offen offset:2048 sc1
  buffer_load_dwordx4 v[100:103], v4, s[64:67], s77 offen offset:3072 sc1
  buffer_load_dwordx4 v[104:107], v4, s[64:67], s78 offen offset:0 sc1
  buffer_load_dwordx4 v[108:111], v4, s[64:67], s78 offen offset:1024 sc1
  buffer_load_dwordx4 v[116:119], v4, s[64:67], s78 offen offset:2048 sc1
  buffer_load_dwordx4 v[124:127], v4, s[64:67], s78 offen offset:3072 sc1
L_ac13:
  s_branch L_Bdone
L_Bx1:
  s_nop 1
  v_smfmac_f32_32x32x32_bf16 v[72:87], v[176:179], v[48:55], v112
  s_cmp_lg_u32 s84, 0
  s_cbranch_scc1 L_ac14
  s_add_u32 m0, s94, 4096
  s_mov_b32 s74, 32768
  buffer_load_dwordx4 v5, s[48:51], s74 offen lds
  s_add_u32 m0, s94, 5120
  s_mov_b32 s74, 40960
  buffer_load_dwordx4 v5, s[48:51], s74 offen lds
  s_add_u32 m0, s94, 6144
  s_mov_b32 s74, 49152
  buffer_load_dwordx4 v5, s[48:51], s74 offen lds
  s_add_u32 m0, s94, 7168
  s_mov_b32 s74, 57344
  buffer_load_dwordx4 v5, s[48:51], s74 offen lds
  s_add_u32 m0, s94, 69632
  s_mov_b32 s74, 0
  buffer_load_dwordx4 v5, s[52:55], s74 offen lds
  s_add_u32 m0, s94, 70656
  s_mov_b32 s74, 8192
  buffer_load_dwordx4 v5, s[52:55], s74 offen lds
  s_add_u32 m0, s94, 71680
  s_mov_b32 s74, 16384
  buffer_load_dwordx4 v5, s[52:55], s74 offen lds
  s_add_u32 m0, s94, 72704
  s_mov_b32 s74, 24576
  buffer_load_dwordx4 v5, s[52:55], s74 offen lds
  s_lshl_b32 s74, s70, 1
  s_and_b32 s75, s3, 1
  s_add_u32 s74, s74, s75
  s_lshl_b32 s74, s74, 2
  s_lshr_b32 s75, s3, 1
  s_add_u32 s74, s74, s75
  s_lshl_b32 s74, s74, 13
  s_add_u32 s77, s74, 6291456
  s_add_u32 s78, s77, 4096
  buffer_load_dwordx4 v[88:91], v4, s[64:67], s77 offen offset:0 sc1
  buffer_load_dwordx4 v[92:95], v4, s[64:67], s77 offen offset:1024 sc1
  buffer_load_dwordx4 v[96:99], v4, s[64:67], s77 offen offset:2048 sc1
  buffer_load_dwordx4 v[100:103], v4, s[64:67], s77 offen offset:3072 sc1
  buffer_load_dwordx4 v[104:107], v4, s[64:67], s78 offen offset:0 sc1
  buffer_load_dwordx4 v[108:111], v4, s[64:67], s78 offen offset:1024 sc1
  buffer_load_dwordx4 v[116:119], v4, s[64:67], s78 offen offset:2048 sc1
  buffer_load_dwordx4 v[124:127], v4, s[64:67], s78 offen offset:3072 sc1
L_ac14:
  s_branch L_Bdone
L_Bx2:
  s_nop 1
  v_smfmac_f32_32x32x32_bf16 v[72:87], v[184:187], v[32:39], v112
  s_cmp_lg_u32 s84, 0
  s_cbranch_scc1 L_ac15
  s_add_u32 m0, s94, 6144
  s_mov_b32 s74, 49152
  buffer_load_dwordx4 v5, s[48:51], s74 offen lds
  s_add_u32 m0, s94, 7168
  s_mov_b32 s74, 57344
  buffer_load_dwordx4 v5, s[48:51], s74 offen lds
  s_add_u32 m0, s94, 69632
  s_mov_b32 s74, 0
  buffer_load_dwordx4 v5, s[52:55], s74 offen lds
  s_add_u32 m0, s94, 70656
  s_mov_b32 s74, 8192
  buffer_load_dwordx4 v5, s[52:55], s74 offen lds
  s_add_u32 m0, s94, 71680
  s_mov_b32 s74, 16384
  buffer_load_dwordx4 v5, s[52:55], s74 offen lds
  s_add_u32 m0, s94, 72704
  s_mov_b32 s74, 24576
  buffer_load_dwordx4 v5, s[52:55], s74 offen lds
  s_lshl_b32 s74, s70, 1
  s_and_b32 s75, s3, 1
  s_add_u32 s74, s74, s75
  s_lshl_b32 s74, s74, 2
  s_lshr_b32 s75, s3, 1
  s_add_u32 s74, s74, s75
  s_lshl_b32 s74, s74, 13
  s_add_u32 s77, s74, 6291456
  s_add_u32 s78, s77, 4096
  buffer_load_dwordx4 v[88:91], v4, s[64:67], s77 offen offset:0 sc1
  buffer_load_dwordx4 v[92:95], v4, s[64:67], s77 offen offset:1024 sc1
  buffer_load_dwordx4 v[96:99], v4, s[64:67], s77 offen offset:2048 sc1
  buffer_load_dwordx4 v[100:103], v4, s[64:67], s77 offen offset:3072 sc1
  buffer_load_dwordx4 v[104:107], v4, s[64:67], s78 offen offset:0 sc1
  buffer_load_dwordx4 v[108:111], v4, s[64:67], s78 offen offset:1024 sc1
  buffer_load_dwordx4 v[116:119], v4, s[64:67], s78 offen offset:2048 sc1
  buffer_load_dwordx4 v[124:127], v4, s[64:67], s78 offen offset:3072 sc1
L_ac15:
  s_branch L_Bdone
L_Bx3:
  s_nop 1
  v_smfmac_f32_32x32x32_bf16 v[72:87], v[192:195], v[48:55], v112
  s_cmp_lg_u32 s84, 0
  s_cbranch_scc1 L_ac16
  s_add_u32 m0, s94, 69632
  s_mov_b32 s74, 0
  buffer_load_dwordx4 v5, s[52:55], s74 offen lds
  s_add_u32 m0, s94, 70656
  s_mov_b32 s74, 8192
  buffer_load_dwordx4 v5, s[52:55], s74 offen lds
  s_add_u32 m0, s94, 71680
  s_mov_b32 s74, 16384
  buffer_load_dwordx4 v5, s[52:55], s74 offen lds
  s_add_u32 m0, s94, 72704
  s_mov_b32 s74, 24576
  buffer_load_dwordx4 v5, s[52:55], s74 offen lds
  s_lshl_b32 s74, s70, 1
  s_and_b32 s75, s3, 1
  s_add_u32 s74, s74, s75
  s_lshl_b32 s74, s74, 2
  s_lshr_b32 s75, s3, 1
  s_add_u32 s74, s74, s75
  s_lshl_b32 s74, s74, 13
  s_add_u32 s77, s74, 6291456
  s_add_u32 s78, s77, 4096
  buffer_load_dwordx4 v[88:91], v4, s[64:67], s77 offen offset:0 sc1
  buffer_load_dwordx4 v[92:95], v4, s[64:67], s77 offen offset:1024 sc1
  buffer_load_dwordx4 v[96:99], v4, s[64:67], s77 offen offset:2048 sc1
  buffer_load_dwordx4 v[100:103], v4, s[64:67], s77 offen offset:3072 sc1
  buffer_load_dwordx4 v[104:107], v4, s[64:67], s78 offen offset:0 sc1
  buffer_load_dwordx4 v[108:111], v4, s[64:67], s78 offen offset:1024 sc1
  buffer_load_dwordx4 v[116:119], v4, s[64:67], s78 offen offset:2048 sc1
  buffer_load_dwordx4 v[124:127], v4, s[64:67], s78 offen offset:3072 sc1
L_ac16:
  s_branch L_Bdone
L_Bx4:
  s_nop 1
  v_smfmac_f32_32x32x32_bf16 v[72:87], v[200:203], v[32:39], v112
  s_cmp_lg_u32 s84, 0
  s_cbranch_scc1 L_ac17
  s_add_u32 m0, s94, 71680
  s_mov_b32 s74, 16384
  buffer_load_dwordx4 v5, s[52:55], s74 offen lds
  s_add_u32 m0, s94, 72704
  s_mov_b32 s74, 24576
  buffer_load_dwordx4 v5, s[52:55], s74 offen lds
  s_lshl_b32 s74, s70, 1
  s_and_b32 s75, s3, 1
  s_add_u32 s74, s74, s75
  s_lshl_b32 s74, s74, 2
  s_lshr_b32 s75, s3, 1
  s_add_u32 s74, s74, s75
  s_lshl_b32 s74, s74, 13
  s_add_u32 s77, s74, 6291456
  s_add_u32 s78, s77, 4096
  buffer_load_dwordx4 v[88:91], v4, s[64:67], s77 offen offset:0 sc1
  buffer_load_dwordx4 v[92:95], v4, s[64:67], s77 offen offset:1024 sc1
  buffer_load_dwordx4 v[96:99], v4, s[64:67], s77 offen offset:2048 sc1
  buffer_load_dwordx4 v[100:103], v4, s[64:67], s77 offen offset:3072 sc1
  buffer_load_dwordx4 v[104:107], v4, s[64:67], s78 offen offset:0 sc1
  buffer_load_dwordx4 v[108:111], v4, s[64:67], s78 offen offset:1024 sc1
  buffer_load_dwordx4 v[116:119], v4, s[64:67], s78 offen offset:2048 sc1
  buffer_load_dwordx4 v[124:127], v4, s[64:67], s78 offen offset:3072 sc1
L_ac17:
  s_branch L_Bdone
L_Bx5:
  s_nop 1
  v_smfmac_f32_32x32x32_bf16 v[72:87], v[208:211], v[48:55], v112
  s_cmp_lg_u32 s84, 0
  s_cbranch_scc1 L_ac18
  s_lshl_b32 s74, s70, 1
  s_and_b32 s75, s3, 1
  s_add_u32 s74, s74, s75
  s_lshl_b32 s74, s74, 2
  s_lshr_b32 s75, s3, 1
  s_add_u32 s74, s74, s75
  s_lshl_b32 s74, s74, 13
  s_add_u32 s77, s74, 6291456
  s_add_u32 s78, s77, 4096
  buffer_load_dwordx4 v[88:91], v4, s[64:67], s77 offen offset:0 sc1
  buffer_load_dwordx4 v[92:95], v4, s[64:67], s77 offen offset:1024 sc1
  buffer_load_dwordx4 v[96:99], v4, s[64:67], s77 offen offset:2048 sc1
  buffer_load_dwordx4 v[100:103], v4, s[64:67], s77 offen offset:3072 sc1
  buffer_load_dwordx4 v[104:107], v4, s[64:67], s78 offen offset:0 sc1
  buffer_load_dwordx4 v[108:111], v4, s[64:67], s78 offen offset:1024 sc1
  buffer_load_dwordx4 v[116:119], v4, s[64:67], s78 offen offset:2048 sc1
  buffer_load_dwordx4 v[124:127], v4, s[64:67], s78 offen offset:3072 sc1
L_ac18:
  s_branch L_Bdone
L_Bx6:
  s_nop 1
  v_smfmac_f32_32x32x32_bf16 v[72:87], v[216:219], v[32:39], v112
  s_cmp_lg_u32 s84, 0
  s_cbranch_scc1 L_ac19
  buffer_load_dwordx4 v[104:107], v4, s[64:67], s78 offen offset:0 sc1
  buffer_load_dwordx4 v[108:111], v4, s[64:67], s78 offen offset:1024 sc1
  buffer_load_dwordx4 v[116:119], v4, s[64:67], s78 offen offset:2048 sc1
  buffer_load_dwordx4 v[124:127], v4, s[64:67], s78 offen offset:3072 sc1
L_ac19:
  s_branch L_Bdone
L_Bx7:
  s_nop 1
  v_smfmac_f32_32x32x32_bf16 v[72:87], v[224:227], v[48:55], v112
  s_cmp_lg_u32 s84, 0
  s_cbranch_scc1 L_ac20
L_ac20:
  s_branch L_Bdone
L_fbA:
  s_mov_b32 s84, 16
  s_mov_b32 s95, 256
  v_add_u32 v113, 94208, v20
  v_mov_b32 v1, 0xff800000
  s_mov_b32 s85, 0
L_fbAl:
  ds_read_b128 v[88:91], v113
  v_add_u32 v113, 1024, v113
  s_waitcnt lgkmcnt(0)
  v_mfma_f32_32x32x16_bf16 v[24:39], v[88:91], v[116:119], 0
  s_nop 7
  s_nop 3
  v_max3_f32 v1, v1, v24, v25
  v_max3_f32 v1, v1, v26, v27
  v_max3_f32 v1, v1, v28, v29
  v_max3_f32 v1, v1, v30, v31
  v_max3_f32 v1, v1, v32, v33
  v_max3_f32 v1, v1, v34, v35
  v_max3_f32 v1, v1, v36, v37
  v_max3_f32 v1, v1, v38, v39
  s_add_u32 s85, s85, 1
  s_cmp_lt_u32 s85, 64
  s_cbranch_scc1 L_fbAl
  v_mov_b32 v2, v1
  s_nop 1
  v_permlane32_swap_b32 v1, v2
  s_nop 0
  v_max_f32 v1, v1, v2
  s_branch L_Arun
L_fbB:
  s_mov_b32 s84, 16
  v_mov_b32 v1, 0xff800000
  v_min_f32 v24, 0, v236
  v_min_f32 v25, 0, v237
  v_min_f32 v26, 0, v238
  v_min_f32 v27, 0, v239
  v_min_f32 v28, 0, v240
  v_min_f32 v29, 0, v241
  v_min_f32 v30, 0, v242
  v_min_f32 v31, 0, v243
  v_min_f32 v32, 0, v244
  v_min_f32 v33, 0, v245
  v_min_f32 v34, 0, v246
  v_min_f32 v35, 0, v247
  v_min_f32 v36, 0, v248
  v_min_f32 v37, 0, v249
  v_min_f32 v38, 0, v250
  v_min_f32 v39, 0, v251
  s_nop 1
  v_mfma_f32_32x32x16_bf16 v[24:39], v[128:131], v[120:123], v[24:39]
  s_nop 7
  s_nop 3
  v_max3_f32 v1, v1, v24, v25
  v_max3_f32 v1, v1, v26, v27
  v_max3_f32 v1, v1, v28, v29
  v_max3_f32 v1, v1, v30, v31
  v_max3_f32 v1, v1, v32, v33
  v_max3_f32 v1, v1, v34, v35
  v_max3_f32 v1, v1, v36, v37
  v_max3_f32 v1, v1, v38, v39
  s_cmp_eq_u32 s86, 0
  s_cbranch_scc1 L_fbBd
  v_mfma_f32_32x32x16_bf16 v[24:39], v[132:135], v[120:123], 0
  s_nop 7
  s_nop 3
  v_max3_f32 v1, v1, v24, v25
  v_max3_f32 v1, v1, v26, v27
  v_max3_f32 v1, v1, v28, v29
  v_max3_f32 v1, v1, v30, v31
  v_max3_f32 v1, v1, v32, v33
  v_max3_f32 v1, v1, v34, v35
  v_max3_f32 v1, v1, v36, v37
  v_max3_f32 v1, v1, v38, v39
  s_cmp_eq_u32 s86, 1
  s_cbranch_scc1 L_fbBd
  v_mfma_f32_32x32x16_bf16 v[24:39], v[136:139], v[120:123], 0
  s_nop 7
  s_nop 3
  v_max3_f32 v1, v1, v24, v25
  v_max3_f32 v1, v1, v26, v27
  v_max3_f32 v1, v1, v28, v29
  v_max3_f32 v1, v1, v30, v31
  v_max3_f32 v1, v1, v32, v33
  v_max3_f32 v1, v1, v34, v35
  v_max3_f32 v1, v1, v36, v37
  v_max3_f32 v1, v1, v38, v39
  s_cmp_eq_u32 s86, 2
  s_cbranch_scc1 L_fbBd
  v_mfma_f32_32x32x16_bf16 v[24:39], v[140:143], v[120:123], 0
  s_nop 7
  s_nop 3
  v_max3_f32 v1, v1, v24, v25
  v_max3_f32 v1, v1, v26, v27
  v_max3_f32 v1, v1, v28, v29
  v_max3_f32 v1, v1, v30, v31
  v_max3_f32 v1, v1, v32, v33
  v_max3_f32 v1, v1, v34, v35
  v_max3_f32 v1, v1, v36, v37
  v_max3_f32 v1, v1, v38, v39
  s_cmp_eq_u32 s86, 3
  s_cbranch_scc1 L_fbBd
  v_mfma_f32_32x32x16_bf16 v[24:39], v[144:147], v[120:123], 0
  s_nop 7
  s_nop 3
  v_max3_f32 v1, v1, v24, v25
  v_max3_f32 v1, v1, v26, v27
  v_max3_f32 v1, v1, v28, v29
  v_max3_f32 v1, v1, v30, v31
  v_max3_f32 v1, v1, v32, v33
  v_max3_f32 v1, v1, v34, v35
  v_max3_f32 v1, v1, v36, v37
  v_max3_f32 v1, v1, v38, v39
  s_cmp_eq_u32 s86, 4
  s_cbranch_scc1 L_fbBd
  v_mfma_f32_32x32x16_bf16 v[24:39], v[148:151], v[120:123], 0
  s_nop 7
  s_nop 3
  v_max3_f32 v1, v1, v24, v25
  v_max3_f32 v1, v1, v26, v27
  v_max3_f32 v1, v1, v28, v29
  v_max3_f32 v1, v1, v30, v31
  v_max3_f32 v1, v1, v32, v33
  v_max3_f32 v1, v1, v34, v35
  v_max3_f32 v1, v1, v36, v37
  v_max3_f32 v1, v1, v38, v39
  s_cmp_eq_u32 s86, 5
  s_cbranch_scc1 L_fbBd
  v_mfma_f32_32x32x16_bf16 v[24:39], v[152:155], v[120:123], 0
  s_nop 7
  s_nop 3
  v_max3_f32 v1, v1, v24, v25
  v_max3_f32 v1, v1, v26, v27
  v_max3_f32 v1, v1, v28, v29
  v_max3_f32 v1, v1, v30, v31
  v_max3_f32 v1, v1, v32, v33
  v_max3_f32 v1, v1, v34, v35
  v_max3_f32 v1, v1, v36, v37
  v_max3_f32 v1, v1, v38, v39
  s_cmp_eq_u32 s86, 6
  s_cbranch_scc1 L_fbBd
  v_mfma_f32_32x32x16_bf16 v[24:39], v[156:159], v[120:123], 0
  s_nop 7
  s_nop 3
  v_max3_f32 v1, v1, v24, v25
  v_max3_f32 v1, v1, v26, v27
  v_max3_f32 v1, v1, v28, v29
  v_max3_f32 v1, v1, v30, v31
  v_max3_f32 v1, v1, v32, v33
  v_max3_f32 v1, v1, v34, v35
  v_max3_f32 v1, v1, v36, v37
  v_max3_f32 v1, v1, v38, v39
  s_cmp_eq_u32 s86, 7
  s_cbranch_scc1 L_fbBd
  v_min_f32_e64 v24, -v236, 0
  v_min_f32_e64 v25, -v237, 0
  v_min_f32_e64 v26, -v238, 0
  v_min_f32_e64 v27, -v239, 0
  v_min_f32_e64 v28, -v240, 0
  v_min_f32_e64 v29, -v241, 0
  v_min_f32_e64 v30, -v242, 0
  v_min_f32_e64 v31, -v243, 0
  v_min_f32_e64 v32, -v244, 0
  v_min_f32_e64 v33, -v245, 0
  v_min_f32_e64 v34, -v246, 0
  v_min_f32_e64 v35, -v247, 0
  v_min_f32_e64 v36, -v248, 0
  v_min_f32_e64 v37, -v249, 0
  v_min_f32_e64 v38, -v250, 0
  v_min_f32_e64 v39, -v251, 0
  s_nop 1
  v_mfma_f32_32x32x16_bf16 v[24:39], v[160:163], v[120:123], v[24:39]
  s_nop 7
  s_nop 3
  v_max3_f32 v1, v1, v24, v25
  v_max3_f32 v1, v1, v26, v27
  v_max3_f32 v1, v1, v28, v29
  v_max3_f32 v1, v1, v30, v31
  v_max3_f32 v1, v1, v32, v33
  v_max3_f32 v1, v1, v34, v35
  v_max3_f32 v1, v1, v36, v37
  v_max3_f32 v1, v1, v38, v39
L_fbBd:
  v_mov_b32 v2, v1
  s_nop 1
  v_permlane32_swap_b32 v1, v2
  s_nop 0
  v_max_f32 v1, v1, v2
  v_mov_b32 v6, v1
  v_min_f32 v24, 0, v236
  v_min_f32 v25, 0, v237
  v_min_f32 v26, 0, v238
  v_min_f32 v27, 0, v239
  v_min_f32 v28, 0, v240
  v_min_f32 v29, 0, v241
  v_min_f32 v30, 0, v242
  v_min_f32 v31, 0, v243
  v_min_f32 v32, 0, v244
  v_min_f32 v33, 0, v245
  v_min_f32 v34, 0, v246
  v_min_f32 v35, 0, v247
  v_min_f32 v36, 0, v248
  v_min_f32 v37, 0, v249
  v_min_f32 v38, 0, v250
  v_min_f32 v39, 0, v251
  s_nop 1
  v_mfma_f32_32x32x16_bf16 v[24:39], v[128:131], v[120:123], v[24:39]
  s_nop 7
  s_nop 3
  s_branch L_Brun
L_or0:
  s_cmp_eq_u32 s87, 0
  s_cbranch_scc1 L_og0
  s_sub_u32 s87, s87, 1
  s_waitcnt vmcnt(0)
  s_mov_b32 s75, 0
  v_max3_u32 v1, v160, v161, v162
  v_max_u32 v1, v1, v163
  v_cmp_eq_u32 vcc, -1, v1
  s_cbranch_vccz L_os0_0
  buffer_load_dwordx4 v[160:163], v4, s[64:67], s77 offen offset:0 sc1
  s_mov_b32 s75, 1
L_os0_0:
  v_max3_u32 v1, v164, v165, v166
  v_max_u32 v1, v1, v167
  v_cmp_eq_u32 vcc, -1, v1
  s_cbranch_vccz L_os0_1
  buffer_load_dwordx4 v[164:167], v4, s[64:67], s77 offen offset:1024 sc1
  s_mov_b32 s75, 1
L_os0_1:
  v_max3_u32 v1, v168, v169, v170
  v_max_u32 v1, v1, v171
  v_cmp_eq_u32 vcc, -1, v1
  s_cbranch_vccz L_os0_2
  buffer_load_dwordx4 v[168:171], v4, s[64:67], s77 offen offset:2048 sc1
  s_mov_b32 s75, 1
L_os0_2:
  v_max3_u32 v1, v172, v173, v174
  v_max_u32 v1, v1, v175
  v_cmp_eq_u32 vcc, -1, v1
  s_cbranch_vccz L_os0_3
  buffer_load_dwordx4 v[172:175], v4, s[64:67], s77 offen offset:3072 sc1
  s_mov_b32 s75, 1
L_os0_3:
  v_max3_u32 v1, v176, v177, v178
  v_max_u32 v1, v1, v179
  v_cmp_eq_u32 vcc, -1, v1
  s_cbranch_vccz L_os0_4
  buffer_load_dwordx4 v[176:179], v4, s[64:67], s78 offen offset:0 sc1
  s_mov_b32 s75, 1
L_os0_4:
  v_max3_u32 v1, v180, v181, v182
  v_max_u32 v1, v1, v183
  v_cmp_eq_u32 vcc, -1, v1
  s_cbranch_vccz L_os0_5
  buffer_load_dwordx4 v[180:183], v4, s[64:67], s78 offen offset:1024 sc1
  s_mov_b32 s75, 1
L_os0_5:
  v_max3_u32 v1, v184, v185, v186
  v_max_u32 v1, v1, v187
  v_cmp_eq_u32 vcc, -1, v1
  s_cbranch_vccz L_os0_6
  buffer_load_dwordx4 v[184:187], v4, s[64:67], s78 offen offset:2048 sc1
  s_mov_b32 s75, 1
L_os0_6:
  v_max3_u32 v1, v188, v189, v190
  v_max_u32 v1, v1, v191
  v_cmp_eq_u32 vcc, -1, v1
  s_cbranch_vccz L_os0_7
  buffer_load_dwordx4 v[188:191], v4, s[64:67], s78 offen offset:3072 sc1
  s_mov_b32 s75, 1
L_os0_7:
  s_cmp_eq_u32 s75, 0
  s_cbranch_scc1 L_og0
  s_branch L_or0
L_or1:
  s_cmp_eq_u32 s87, 0
  s_cbranch_scc1 L_og1
  s_sub_u32 s87, s87, 1
  s_waitcnt vmcnt(0)
  s_mov_b32 s75, 0
  v_max3_u32 v1, v164, v165, v166
  v_max_u32 v1, v1, v167
  v_cmp_eq_u32 vcc, -1, v1
  s_cbranch_vccz L_os1_1
  buffer_load_dwordx4 v[164:167], v4, s[64:67], s77 offen offset:1024 sc1
  s_mov_b32 s75, 1
L_os1_1:
  v_max3_u32 v1, v168, v169, v170
  v_max_u32 v1, v1, v171
  v_cmp_eq_u32 vcc, -1, v1
  s_cbranch_vccz L_os1_2
  buffer_load_dwordx4 v[168:171], v4, s[64:67], s77 offen offset:2048 sc1
  s_mov_b32 s75, 1
L_os1_2:
  v_max3_u32 v1, v172, v173, v174
  v_max_u32 v1, v1, v175
  v_cmp_eq_u32 vcc, -1, v1
  s_cbranch_vccz L_os1_3
  buffer_load_dwordx4 v[172:175], v4, s[64:67], s77 offen offset:3072 sc1
  s_mov_b32 s75, 1
L_os1_3:
  v_max3_u32 v1, v176, v177, v178
  v_max_u32 v1, v1, v179
  v_cmp_eq_u32 vcc, -1, v1
  s_cbranch_vccz L_os1_4
  buffer_load_dwordx4 v[176:179], v4, s[64:67], s78 offen offset:0 sc1
  s_mov_b32 s75, 1
L_os1_4:
  v_max3_u32 v1, v180, v181, v182
  v_max_u32 v1, v1, v183
  v_cmp_eq_u32 vcc, -1, v1
  s_cbranch_vccz L_os1_5
  buffer_load_dwordx4 v[180:183], v4, s[64:67], s78 offen offset:1024 sc1
  s_mov_b32 s75, 1
L_os1_5:
  v_max3_u32 v1, v184, v185, v186
  v_max_u32 v1, v1, v187
  v_cmp_eq_u32 vcc, -1, v1
  s_cbranch_vccz L_os1_6
  buffer_load_dwordx4 v[184:187], v4, s[64:67], s78 offen offset:2048 sc1
  s_mov_b32 s75, 1
L_os1_6:
  v_max3_u32 v1, v188, v189, v190
  v_max_u32 v1, v1, v191
  v_cmp_eq_u32 vcc, -1, v1
  s_cbranch_vccz L_os1_7
  buffer_load_dwordx4 v[188:191], v4, s[64:67], s78 offen offset:3072 sc1
  s_mov_b32 s75, 1
L_os1_7:
  s_cmp_eq_u32 s75, 0
  s_cbranch_scc1 L_og1
  s_branch L_or1
L_or2:
  s_cmp_eq_u32 s87, 0
  s_cbranch_scc1 L_og2
  s_sub_u32 s87, s87, 1
  s_waitcnt vmcnt(0)
  s_mov_b32 s75, 0
  v_max3_u32 v1, v168, v169, v170
  v_max_u32 v1, v1, v171
  v_cmp_eq_u32 vcc, -1, v1
  s_cbranch_vccz L_os2_2
  buffer_load_dwordx4 v[168:171], v4, s[64:67], s77 offen offset:2048 sc1
  s_mov_b32 s75, 1
L_os2_2:
  v_max3_u32 v1, v172, v173, v174
  v_max_u32 v1, v1, v175
  v_cmp_eq_u32 vcc, -1, v1
  s_cbranch_vccz L_os2_3
  buffer_load_dwordx4 v[172:175], v4, s[64:67], s77 offen offset:3072 sc1
  s_mov_b32 s75, 1
L_os2_3:
  v_max3_u32 v1, v176, v177, v178
  v_max_u32 v1, v1, v179
  v_cmp_eq_u32 vcc, -1, v1
  s_cbranch_vccz L_os2_4
  buffer_load_dwordx4 v[176:179], v4, s[64:67], s78 offen offset:0 sc1
  s_mov_b32 s75, 1
L_os2_4:
  v_max3_u32 v1, v180, v181, v182
  v_max_u32 v1, v1, v183
  v_cmp_eq_u32 vcc, -1, v1
  s_cbranch_vccz L_os2_5
  buffer_load_dwordx4 v[180:183], v4, s[64:67], s78 offen offset:1024 sc1
  s_mov_b32 s75, 1
L_os2_5:
  v_max3_u32 v1, v184, v185, v186
  v_max_u32 v1, v1, v187
  v_cmp_eq_u32 vcc, -1, v1
  s_cbranch_vccz L_os2_6
  buffer_load_dwordx4 v[184:187], v4, s[64:67], s78 offen offset:2048 sc1
  s_mov_b32 s75, 1
L_os2_6:
  v_max3_u32 v1, v188, v189, v190
  v_max_u32 v1, v1, v191
  v_cmp_eq_u32 vcc, -1, v1
  s_cbranch_vccz L_os2_7
  buffer_load_dwordx4 v[188:191], v4, s[64:67], s78 offen offset:3072 sc1
  s_mov_b32 s75, 1
L_os2_7:
  s_cmp_eq_u32 s75, 0
  s_cbranch_scc1 L_og2
  s_branch L_or2
L_or3:
  s_cmp_eq_u32 s87, 0
  s_cbranch_scc1 L_og3
  s_sub_u32 s87, s87, 1
  s_waitcnt vmcnt(0)
  s_mov_b32 s75, 0
  v_max3_u32 v1, v172, v173, v174
  v_max_u32 v1, v1, v175
  v_cmp_eq_u32 vcc, -1, v1
  s_cbranch_vccz L_os3_3
  buffer_load_dwordx4 v[172:175], v4, s[64:67], s77 offen offset:3072 sc1
  s_mov_b32 s75, 1
L_os3_3:
  v_max3_u32 v1, v176, v177, v178
  v_max_u32 v1, v1, v179
  v_cmp_eq_u32 vcc, -1, v1
  s_cbranch_vccz L_os3_4
  buffer_load_dwordx4 v[176:179], v4, s[64:67], s78 offen offset:0 sc1
  s_mov_b32 s75, 1
L_os3_4:
  v_max3_u32 v1, v180, v181, v182
  v_max_u32 v1, v1, v183
  v_cmp_eq_u32 vcc, -1, v1
  s_cbranch_vccz L_os3_5
  buffer_load_dwordx4 v[180:183], v4, s[64:67], s78 offen offset:1024 sc1
  s_mov_b32 s75, 1
L_os3_5:
  v_max3_u32 v1, v184, v185, v186
  v_max_u32 v1, v1, v187
  v_cmp_eq_u32 vcc, -1, v1
  s_cbranch_vccz L_os3_6
  buffer_load_dwordx4 v[184:187], v4, s[64:67], s78 offen offset:2048 sc1
  s_mov_b32 s75, 1
L_os3_6:
  v_max3_u32 v1, v188, v189, v190
  v_max_u32 v1, v1, v191
  v_cmp_eq_u32 vcc, -1, v1
  s_cbranch_vccz L_os3_7
  buffer_load_dwordx4 v[188:191], v4, s[64:67], s78 offen offset:3072 sc1
  s_mov_b32 s75, 1
L_os3_7:
  s_cmp_eq_u32 s75, 0
  s_cbranch_scc1 L_og3
  s_branch L_or3
L_or4:
  s_cmp_eq_u32 s87, 0
  s_cbranch_scc1 L_og4
  s_sub_u32 s87, s87, 1
  s_waitcnt vmcnt(0)
  s_mov_b32 s75, 0
  v_max3_u32 v1, v176, v177, v178
  v_max_u32 v1, v1, v179
  v_cmp_eq_u32 vcc, -1, v1
  s_cbranch_vccz L_os4_4
  buffer_load_dwordx4 v[176:179], v4, s[64:67], s78 offen offset:0 sc1
  s_mov_b32 s75, 1
L_os4_4:
  v_max3_u32 v1, v180, v181, v182
  v_max_u32 v1, v1, v183
  v_cmp_eq_u32 vcc, -1, v1
  s_cbranch_vccz L_os4_5
  buffer_load_dwordx4 v[180:183], v4, s[64:67], s78 offen offset:1024 sc1
  s_mov_b32 s75, 1
L_os4_5:
  v_max3_u32 v1, v184, v185, v186
  v_max_u32 v1, v1, v187
  v_cmp_eq_u32 vcc, -1, v1
  s_cbranch_vccz L_os4_6
  buffer_load_dwordx4 v[184:187], v4, s[64:67], s78 offen offset:2048 sc1
  s_mov_b32 s75, 1
L_os4_6:
  v_max3_u32 v1, v188, v189, v190
  v_max_u32 v1, v1, v191
  v_cmp_eq_u32 vcc, -1, v1
  s_cbranch_vccz L_os4_7
  buffer_load_dwordx4 v[188:191], v4, s[64:67], s78 offen offset:3072 sc1
  s_mov_b32 s75, 1
L_os4_7:
  s_cmp_eq_u32 s75, 0
  s_cbranch_scc1 L_og4
  s_branch L_or4
L_or5:
  s_cmp_eq_u32 s87, 0
  s_cbranch_scc1 L_og5
  s_sub_u32 s87, s87, 1
  s_waitcnt vmcnt(0)
  s_mov_b32 s75, 0
  v_max3_u32 v1, v180, v181, v182
  v_max_u32 v1, v1, v183
  v_cmp_eq_u32 vcc, -1, v1
  s_cbranch_vccz L_os5_5
  buffer_load_dwordx4 v[180:183], v4, s[64:67], s78 offen offset:1024 sc1
  s_mov_b32 s75, 1
L_os5_5:
  v_max3_u32 v1, v184, v185, v186
  v_max_u32 v1, v1, v187
  v_cmp_eq_u32 vcc, -1, v1
  s_cbranch_vccz L_os5_6
  buffer_load_dwordx4 v[184:187], v4, s[64:67], s78 offen offset:2048 sc1
  s_mov_b32 s75, 1
L_os5_6:
  v_max3_u32 v1, v188, v189, v190
  v_max_u32 v1, v1, v191
  v_cmp_eq_u32 vcc, -1, v1
  s_cbranch_vccz L_os5_7
  buffer_load_dwordx4 v[188:191], v4, s[64:67], s78 offen offset:3072 sc1
  s_mov_b32 s75, 1
L_os5_7:
  s_cmp_eq_u32 s75, 0
  s_cbranch_scc1 L_og5
  s_branch L_or5
L_or6:
  s_cmp_eq_u32 s87, 0
  s_cbranch_scc1 L_og6
  s_sub_u32 s87, s87, 1
  s_waitcnt vmcnt(0)
  s_mov_b32 s75, 0
  v_max3_u32 v1, v184, v185, v186
  v_max_u32 v1, v1, v187
  v_cmp_eq_u32 vcc, -1, v1
  s_cbranch_vccz L_os6_6
  buffer_load_dwordx4 v[184:187], v4, s[64:67], s78 offen offset:2048 sc1
  s_mov_b32 s75, 1
L_os6_6:
  v_max3_u32 v1, v188, v189, v190
  v_max_u32 v1, v1, v191
  v_cmp_eq_u32 vcc, -1, v1
  s_cbranch_vccz L_os6_7
  buffer_load_dwordx4 v[188:191], v4, s[64:67], s78 offen offset:3072 sc1
  s_mov_b32 s75, 1
L_os6_7:
  s_cmp_eq_u32 s75, 0
  s_cbranch_scc1 L_og6
  s_branch L_or6
L_or7:
  s_cmp_eq_u32 s87, 0
  s_cbranch_scc1 L_og7
  s_sub_u32 s87, s87, 1
  s_waitcnt vmcnt(0)
  s_mov_b32 s75, 0
  v_max3_u32 v1, v188, v189, v190
  v_max_u32 v1, v1, v191
  v_cmp_eq_u32 vcc, -1, v1
  s_cbranch_vccz L_os7_7
  buffer_load_dwordx4 v[188:191], v4, s[64:67], s78 offen offset:3072 sc1
  s_mov_b32 s75, 1
L_os7_7:
  s_cmp_eq_u32 s75, 0
  s_cbranch_scc1 L_og7
  s_branch L_or7
L_ar0:
  s_cmp_eq_u32 s87, 0
  s_cbranch_scc1 L_ag0
  s_sub_u32 s87, s87, 1
  s_waitcnt vmcnt(0)
  s_mov_b32 s75, 0
  v_max3_u32 v1, v88, v89, v90
  v_max_u32 v1, v1, v91
  v_cmp_eq_u32 vcc, -1, v1
  s_cbranch_vccz L_as0_0
  buffer_load_dwordx4 v[88:91], v4, s[64:67], s77 offen offset:0 sc1
  s_mov_b32 s75, 1
L_as0_0:
  v_max3_u32 v1, v92, v93, v94
  v_max_u32 v1, v1, v95
  v_cmp_eq_u32 vcc, -1, v1
  s_cbranch_vccz L_as0_1
  buffer_load_dwordx4 v[92:95], v4, s[64:67], s77 offen offset:1024 sc1
  s_mov_b32 s75, 1
L_as0_1:
  v_max3_u32 v1, v96, v97, v98
  v_max_u32 v1, v1, v99
  v_cmp_eq_u32 vcc, -1, v1
  s_cbranch_vccz L_as0_2
  buffer_load_dwordx4 v[96:99], v4, s[64:67], s77 offen offset:2048 sc1
  s_mov_b32 s75, 1
L_as0_2:
  v_max3_u32 v1, v100, v101, v102
  v_max_u32 v1, v1, v103
  v_cmp_eq_u32 vcc, -1, v1
  s_cbranch_vccz L_as0_3
  buffer_load_dwordx4 v[100:103], v4, s[64:67], s77 offen offset:3072 sc1
  s_mov_b32 s75, 1
L_as0_3:
  v_max3_u32 v1, v104, v105, v106
  v_max_u32 v1, v1, v107
  v_cmp_eq_u32 vcc, -1, v1
  s_cbranch_vccz L_as0_4
  buffer_load_dwordx4 v[104:107], v4, s[64:67], s78 offen offset:0 sc1
  s_mov_b32 s75, 1
L_as0_4:
  v_max3_u32 v1, v108, v109, v110
  v_max_u32 v1, v1, v111
  v_cmp_eq_u32 vcc, -1, v1
  s_cbranch_vccz L_as0_5
  buffer_load_dwordx4 v[108:111], v4, s[64:67], s78 offen offset:1024 sc1
  s_mov_b32 s75, 1
L_as0_5:
  v_max3_u32 v1, v116, v117, v118
  v_max_u32 v1, v1, v119
  v_cmp_eq_u32 vcc, -1, v1
  s_cbranch_vccz L_as0_6
  buffer_load_dwordx4 v[116:119], v4, s[64:67], s78 offen offset:2048 sc1
  s_mov_b32 s75, 1
L_as0_6:
  v_max3_u32 v1, v124, v125, v126
  v_max_u32 v1, v1, v127
  v_cmp_eq_u32 vcc, -1, v1
  s_cbranch_vccz L_as0_7
  buffer_load_dwordx4 v[124:127], v4, s[64:67], s78 offen offset:3072 sc1
  s_mov_b32 s75, 1
L_as0_7:
  s_cmp_eq_u32 s75, 0
  s_cbranch_scc1 L_ag0
  s_branch L_ar0
L_ar1:
  s_cmp_eq_u32 s87, 0
  s_cbranch_scc1 L_ag1
  s_sub_u32 s87, s87, 1
  s_waitcnt vmcnt(0)
  s_mov_b32 s75, 0
  v_max3_u32 v1, v92, v93, v94
  v_max_u32 v1, v1, v95
  v_cmp_eq_u32 vcc, -1, v1
  s_cbranch_vccz L_as1_1
  buffer_load_dwordx4 v[92:95], v4, s[64:67], s77 offen offset:1024 sc1
  s_mov_b32 s75, 1
L_as1_1:
  v_max3_u32 v1, v96, v97, v98
  v_max_u32 v1, v1, v99
  v_cmp_eq_u32 vcc, -1, v1
  s_cbranch_vccz L_as1_2
  buffer_load_dwordx4 v[96:99], v4, s[64:67], s77 offen offset:2048 sc1
  s_mov_b32 s75, 1
L_as1_2:
  v_max3_u32 v1, v100, v101, v102
  v_max_u32 v1, v1, v103
  v_cmp_eq_u32 vcc, -1, v1
  s_cbranch_vccz L_as1_3
  buffer_load_dwordx4 v[100:103], v4, s[64:67], s77 offen offset:3072 sc1
  s_mov_b32 s75, 1
L_as1_3:
  v_max3_u32 v1, v104, v105, v106
  v_max_u32 v1, v1, v107
  v_cmp_eq_u32 vcc, -1, v1
  s_cbranch_vccz L_as1_4
  buffer_load_dwordx4 v[104:107], v4, s[64:67], s78 offen offset:0 sc1
  s_mov_b32 s75, 1
L_as1_4:
  v_max3_u32 v1, v108, v109, v110
  v_max_u32 v1, v1, v111
  v_cmp_eq_u32 vcc, -1, v1
  s_cbranch_vccz L_as1_5
  buffer_load_dwordx4 v[108:111], v4, s[64:67], s78 offen offset:1024 sc1
  s_mov_b32 s75, 1
L_as1_5:
  v_max3_u32 v1, v116, v117, v118
  v_max_u32 v1, v1, v119
  v_cmp_eq_u32 vcc, -1, v1
  s_cbranch_vccz L_as1_6
  buffer_load_dwordx4 v[116:119], v4, s[64:67], s78 offen offset:2048 sc1
  s_mov_b32 s75, 1
L_as1_6:
  v_max3_u32 v1, v124, v125, v126
  v_max_u32 v1, v1, v127
  v_cmp_eq_u32 vcc, -1, v1
  s_cbranch_vccz L_as1_7
  buffer_load_dwordx4 v[124:127], v4, s[64:67], s78 offen offset:3072 sc1
  s_mov_b32 s75, 1
L_as1_7:
  s_cmp_eq_u32 s75, 0
  s_cbranch_scc1 L_ag1
  s_branch L_ar1
L_ar2:
  s_cmp_eq_u32 s87, 0
  s_cbranch_scc1 L_ag2
  s_sub_u32 s87, s87, 1
  s_waitcnt vmcnt(0)
  s_mov_b32 s75, 0
  v_max3_u32 v1, v96, v97, v98
  v_max_u32 v1, v1, v99
  v_cmp_eq_u32 vcc, -1, v1
  s_cbranch_vccz L_as2_2
  buffer_load_dwordx4 v[96:99], v4, s[64:67], s77 offen offset:2048 sc1
  s_mov_b32 s75, 1
L_as2_2:
  v_max3_u32 v1, v100, v101, v102
  v_max_u32 v1, v1, v103
  v_cmp_eq_u32 vcc, -1, v1
  s_cbranch_vccz L_as2_3
  buffer_load_dwordx4 v[100:103], v4, s[64:67], s77 offen offset:3072 sc1
  s_mov_b32 s75, 1
L_as2_3:
  v_max3_u32 v1, v104, v105, v106
  v_max_u32 v1, v1, v107
  v_cmp_eq_u32 vcc, -1, v1
  s_cbranch_vccz L_as2_4
  buffer_load_dwordx4 v[104:107], v4, s[64:67], s78 offen offset:0 sc1
  s_mov_b32 s75, 1
L_as2_4:
  v_max3_u32 v1, v108, v109, v110
  v_max_u32 v1, v1, v111
  v_cmp_eq_u32 vcc, -1, v1
  s_cbranch_vccz L_as2_5
  buffer_load_dwordx4 v[108:111], v4, s[64:67], s78 offen offset:1024 sc1
  s_mov_b32 s75, 1
L_as2_5:
  v_max3_u32 v1, v116, v117, v118
  v_max_u32 v1, v1, v119
  v_cmp_eq_u32 vcc, -1, v1
  s_cbranch_vccz L_as2_6
  buffer_load_dwordx4 v[116:119], v4, s[64:67], s78 offen offset:2048 sc1
  s_mov_b32 s75, 1
L_as2_6:
  v_max3_u32 v1, v124, v125, v126
  v_max_u32 v1, v1, v127
  v_cmp_eq_u32 vcc, -1, v1
  s_cbranch_vccz L_as2_7
  buffer_load_dwordx4 v[124:127], v4, s[64:67], s78 offen offset:3072 sc1
  s_mov_b32 s75, 1
L_as2_7:
  s_cmp_eq_u32 s75, 0
  s_cbranch_scc1 L_ag2
  s_branch L_ar2
L_ar3:
  s_cmp_eq_u32 s87, 0
  s_cbranch_scc1 L_ag3
  s_sub_u32 s87, s87, 1
  s_waitcnt vmcnt(0)
  s_mov_b32 s75, 0
  v_max3_u32 v1, v100, v101, v102
  v_max_u32 v1, v1, v103
  v_cmp_eq_u32 vcc, -1, v1
  s_cbranch_vccz L_as3_3
  buffer_load_dwordx4 v[100:103], v4, s[64:67], s77 offen offset:3072 sc1
  s_mov_b32 s75, 1
L_as3_3:
  v_max3_u32 v1, v104, v105, v106
  v_max_u32 v1, v1, v107
  v_cmp_eq_u32 vcc, -1, v1
  s_cbranch_vccz L_as3_4
  buffer_load_dwordx4 v[104:107], v4, s[64:67], s78 offen offset:0 sc1
  s_mov_b32 s75, 1
L_as3_4:
  v_max3_u32 v1, v108, v109, v110
  v_max_u32 v1, v1, v111
  v_cmp_eq_u32 vcc, -1, v1
  s_cbranch_vccz L_as3_5
  buffer_load_dwordx4 v[108:111], v4, s[64:67], s78 offen offset:1024 sc1
  s_mov_b32 s75, 1
L_as3_5:
  v_max3_u32 v1, v116, v117, v118
  v_max_u32 v1, v1, v119
  v_cmp_eq_u32 vcc, -1, v1
  s_cbranch_vccz L_as3_6
  buffer_load_dwordx4 v[116:119], v4, s[64:67], s78 offen offset:2048 sc1
  s_mov_b32 s75, 1
L_as3_6:
  v_max3_u32 v1, v124, v125, v126
  v_max_u32 v1, v1, v127
  v_cmp_eq_u32 vcc, -1, v1
  s_cbranch_vccz L_as3_7
  buffer_load_dwordx4 v[124:127], v4, s[64:67], s78 offen offset:3072 sc1
  s_mov_b32 s75, 1
L_as3_7:
  s_cmp_eq_u32 s75, 0
  s_cbranch_scc1 L_ag3
  s_branch L_ar3
L_ar4:
  s_cmp_eq_u32 s87, 0
  s_cbranch_scc1 L_ag4
  s_sub_u32 s87, s87, 1
  s_waitcnt vmcnt(0)
  s_mov_b32 s75, 0
  v_max3_u32 v1, v104, v105, v106
  v_max_u32 v1, v1, v107
  v_cmp_eq_u32 vcc, -1, v1
  s_cbranch_vccz L_as4_4
  buffer_load_dwordx4 v[104:107], v4, s[64:67], s78 offen offset:0 sc1
  s_mov_b32 s75, 1
L_as4_4:
  v_max3_u32 v1, v108, v109, v110
  v_max_u32 v1, v1, v111
  v_cmp_eq_u32 vcc, -1, v1
  s_cbranch_vccz L_as4_5
  buffer_load_dwordx4 v[108:111], v4, s[64:67], s78 offen offset:1024 sc1
  s_mov_b32 s75, 1
L_as4_5:
  v_max3_u32 v1, v116, v117, v118
  v_max_u32 v1, v1, v119
  v_cmp_eq_u32 vcc, -1, v1
  s_cbranch_vccz L_as4_6
  buffer_load_dwordx4 v[116:119], v4, s[64:67], s78 offen offset:2048 sc1
  s_mov_b32 s75, 1
L_as4_6:
  v_max3_u32 v1, v124, v125, v126
  v_max_u32 v1, v1, v127
  v_cmp_eq_u32 vcc, -1, v1
  s_cbranch_vccz L_as4_7
  buffer_load_dwordx4 v[124:127], v4, s[64:67], s78 offen offset:3072 sc1
  s_mov_b32 s75, 1
L_as4_7:
  s_cmp_eq_u32 s75, 0
  s_cbranch_scc1 L_ag4
  s_branch L_ar4
L_ar5:
  s_cmp_eq_u32 s87, 0
  s_cbranch_scc1 L_ag5
  s_sub_u32 s87, s87, 1
  s_waitcnt vmcnt(0)
  s_mov_b32 s75, 0
  v_max3_u32 v1, v108, v109, v110
  v_max_u32 v1, v1, v111
  v_cmp_eq_u32 vcc, -1, v1
  s_cbranch_vccz L_as5_5
  buffer_load_dwordx4 v[108:111], v4, s[64:67], s78 offen offset:1024 sc1
  s_mov_b32 s75, 1
L_as5_5:
  v_max3_u32 v1, v116, v117, v118
  v_max_u32 v1, v1, v119
  v_cmp_eq_u32 vcc, -1, v1
  s_cbranch_vccz L_as5_6
  buffer_load_dwordx4 v[116:119], v4, s[64:67], s78 offen offset:2048 sc1
  s_mov_b32 s75, 1
L_as5_6:
  v_max3_u32 v1, v124, v125, v126
  v_max_u32 v1, v1, v127
  v_cmp_eq_u32 vcc, -1, v1
  s_cbranch_vccz L_as5_7
  buffer_load_dwordx4 v[124:127], v4, s[64:67], s78 offen offset:3072 sc1
  s_mov_b32 s75, 1
L_as5_7:
  s_cmp_eq_u32 s75, 0
  s_cbranch_scc1 L_ag5
  s_branch L_ar5
L_ar6:
  s_cmp_eq_u32 s87, 0
  s_cbranch_scc1 L_ag6
  s_sub_u32 s87, s87, 1
  s_waitcnt vmcnt(0)
  s_mov_b32 s75, 0
  v_max3_u32 v1, v116, v117, v118
  v_max_u32 v1, v1, v119
  v_cmp_eq_u32 vcc, -1, v1
  s_cbranch_vccz L_as6_6
  buffer_load_dwordx4 v[116:119], v4, s[64:67], s78 offen offset:2048 sc1
  s_mov_b32 s75, 1
L_as6_6:
  v_max3_u32 v1, v124, v125, v126
  v_max_u32 v1, v1, v127
  v_cmp_eq_u32 vcc, -1, v1
  s_cbranch_vccz L_as6_7
  buffer_load_dwordx4 v[124:127], v4, s[64:67], s78 offen offset:3072 sc1
  s_mov_b32 s75, 1
L_as6_7:
  s_cmp_eq_u32 s75, 0
  s_cbranch_scc1 L_ag6
  s_branch L_ar6
L_ar7:
  s_cmp_eq_u32 s87, 0
  s_cbranch_scc1 L_ag7
  s_sub_u32 s87, s87, 1
  s_waitcnt vmcnt(0)
  s_mov_b32 s75, 0
  v_max3_u32 v1, v124, v125, v126
  v_max_u32 v1, v1, v127
  v_cmp_eq_u32 vcc, -1, v1
  s_cbranch_vccz L_as7_7
  buffer_load_dwordx4 v[124:127], v4, s[64:67], s78 offen offset:3072 sc1
  s_mov_b32 s75, 1
L_as7_7:
  s_cmp_eq_u32 s75, 0
  s_cbranch_scc1 L_ag7
  s_branch L_ar7
  .section .rodata,"a"
  .p2align 6
  .amdhsa_kernel concat_heads__grouped_kv_mqa__sliding_block__prompt_kernel
  .amdhsa_next_free_vgpr 256
  .amdhsa_next_free_sgpr 102
  .amdhsa_accum_offset 256
  .amdhsa_group_segment_fixed_size 0
  .amdhsa_kernarg_size 88
  .amdhsa_user_sgpr_count 2
  .amdhsa_user_sgpr_kernarg_segment_ptr 1
  .amdhsa_system_sgpr_workgroup_id_x 1
  .end_amdhsa_kernel
```
